```python
import torch

def _softmax(x, axis=-1):
    return torch.softmax(x, dim=axis)
def _gelu(x):
    return torch.nn.functional.gelu(x, approximate="tanh")
def _silu(x):
    return torch.nn.functional.silu(x)
def _sigmoid(x):
    return torch.sigmoid(x)
def _layernorm(x, axis=-1, eps=1e-5):
    m = x.mean(dim=axis, keepdim=True)
    v = x.var(dim=axis, keepdim=True, unbiased=False)
    return (x - m) / torch.sqrt(v + eps)
def _scatter_add(tgt, idx, src, axis=0):
    return tgt.clone().index_add_(axis, idx, src)
def _segment_sum(src, seg, n):
    out = torch.zeros((n,) + src.shape[1:], dtype=src.dtype)
    return out.index_add_(0, seg, src)
def _pad(x, pw):
    flat = tuple(v for pair in reversed(pw) for v in pair)
    return torch.nn.functional.pad(x, flat)

kernel_name = 'sequential_preLN__spectral_fnet__glu_gated_glu__prompt'

def setup_inputs():

    _w = (lambda a: (lambda t: t.to(torch.bfloat16) if t.is_floating_point() else t)(torch.as_tensor(a)))
    def _A_setup():
        B, S, D = 1, 2048, 640
        ns = torch.arange(S)[:, None] * torch.arange(S)[None, :]
        nd = torch.arange(D)[:, None] * torch.arange(D)[None, :]
        Ws_re = torch.cos(-2.0 * torch.pi * ns / S).to(float)
        Ws_im = torch.sin(-2.0 * torch.pi * ns / S).to(float)
        Wd_re = torch.cos(-2.0 * torch.pi * nd / D).to(float)
        Wd_im = torch.sin(-2.0 * torch.pi * nd / D).to(float)
        return {
            "x": _w((lambda *s: torch.randn(*s, dtype=torch.bfloat16) * 0.05)(B, S, D)),
            "dft_seq_re": _w(Ws_re),
            "dft_seq_im": _w(Ws_im),
            "dft_hid_re": _w(Wd_re),
            "dft_hid_im": _w(Wd_im),
        }
    _A_in = _A_setup()

    def _B_setup():
        B, S, D, F = 1, 2048, 640, 1536
        return {
            "x": _w((lambda *s: torch.randn(*s, dtype=torch.bfloat16) * 0.05)(B, S, D)),
            "w_gate": _w((lambda *s: torch.randn(*s, dtype=torch.bfloat16) * 1.6)(D, F)),
            "w_up": _w((lambda *s: torch.randn(*s, dtype=torch.bfloat16) * 0.8)(D, F)),
            "w_down": _w((lambda *s: torch.randn(*s, dtype=torch.bfloat16) * 0.8)(F, D)),
        }
    _B_in = _B_setup()

    return {
        "A_x": _A_in["x"],
        "A_dft_seq_re": _A_in["dft_seq_re"],
        "A_dft_seq_im": _A_in["dft_seq_im"],
        "A_dft_hid_re": _A_in["dft_hid_re"],
        "A_dft_hid_im": _A_in["dft_hid_im"],
        "B_x": _B_in["x"],
        "B_w_gate": _B_in["w_gate"],
        "B_w_up": _B_in["w_up"],
        "B_w_down": _B_in["w_down"],
    }

def reference(A_x, A_dft_seq_re, A_dft_seq_im, A_dft_hid_re, A_dft_hid_im, B_x, B_w_gate, B_w_up, B_w_down):
    def _A_ref(x, dft_seq_re, dft_seq_im, dft_hid_re, dft_hid_im):
        a = torch.einsum("bsd,ed->bse", x, dft_hid_re)
        b = torch.einsum("bsd,ed->bse", x, dft_hid_im)
        y = torch.einsum("ts,bse->bte", dft_seq_re, a) - torch.einsum("ts,bse->bte", dft_seq_im, b)
        return y

    def _B_ref(x, w_gate, w_up, w_down):
        g = torch.einsum("bsd,df->bsf", x, w_gate)
        u = torch.einsum("bsd,df->bsf", x, w_up)
        h = _sigmoid(g) * u
        return torch.einsum("bsf,fd->bsd", h, w_down)

    x = A_x
    h = x + _A_ref(_layernorm(x, axis=-1), A_dft_seq_re, A_dft_seq_im, A_dft_hid_re, A_dft_hid_im)
    h2 = h + _B_ref(_layernorm(h, axis=-1), B_w_gate, B_w_up, B_w_down)
    return h2
```

```asm
; @launch grid=(256,1,1) block=(256,1,1) lds=163840
.amdgcn_target "amdgcn-amd-amdhsa--gfx950"
.text
.globl sequential_preLN__spectral_fnet__glu_gated_glu__prompt_kernel
.p2align 8
.type sequential_preLN__spectral_fnet__glu_gated_glu__prompt_kernel,@function
sequential_preLN__spectral_fnet__glu_gated_glu__prompt_kernel:
    s_getpc_b64 s[62:63]
    s_load_dwordx2 s[4:5], s[0:1], 0
    s_load_dwordx2 s[8:9], s[0:1], 88
    s_load_dwordx4 s[44:47], s[0:1], 48
    s_load_dwordx4 s[40:43], s[0:1], 64
    s_cmp_ge_u32 s2, 256
    s_cbranch_scc1 L_end
    s_bfe_u32 s30, s2, 0x30003
    s_lshl_b32 s3, s30, 12
    v_lshl_add_u32 v5, v0, 4, s3
    global_load_dwordx4 v[252:255], v5, s[62:63]
    v_lshrrev_b32 v4, 6, v0
    v_and_b32 v1, 63, v0
    v_readfirstlane_b32 s28, v4
    v_lshrrev_b32 v5, 3, v1
    v_and_b32 v6, 6, v5
    v_and_b32 v7, 7, v1
    v_xor_b32 v6, v6, v7
    s_and_b32 s29, s2, 7
    s_cselect_b32 s31, s29, 8
    s_sub_u32 s31, 16, s31
    s_bitcmp1_b32 s2, 6
    s_cselect_b32 s29, s31, s29
    s_lshr_b32 s3, s2, 7
    s_lshl_b32 s3, s3, 4
    s_add_u32 s29, s29, s3
    s_sub_u32 s31, 64, s29
    s_cmp_eq_u32 s29, 0
    s_cselect_b32 s31, 32, s31
    s_cmp_lt_u32 s28, 2
    s_cselect_b32 s48, s29, s31
    s_mul_i32 s48, s48, 1280
    s_mul_i32 s35, s28, 20480
    s_and_b32 s37, s28, 1
    s_lshl_b32 s39, s37, 4
    v_add_u32 v11, s39, v5
    v_mul_u32_u24 v11, 81920, v11
    v_lshl_add_u32 v11, v6, 4, v11
    v_add_u32 v15, 654336, v11
    s_mov_b32 s6, 2621440
    s_mov_b32 s7, 0x20000
    v_and_b32 v2, 15, v0
    v_bfe_u32 v3, v0, 4, 2
    v_lshlrev_b32 v4, 4, v1
    s_mul_i32 s3, s30, 40
    v_cmp_gt_u32 vcc, 8, v2
    v_add_u32 v16, s3, v2
    v_add_u32 v17, 16, v16
    v_add_u32 v30, 32, v16
    v_subrev_u32 v31, 8, v16
    v_cndmask_b32 v18, v31, v30, vcc
    v_add_u32 v19, 8, v16
    v_add_u32 v20, 24, v16
    s_mov_b32 s24, 0x3e800000
    v_mov_b32 v30, s24
    v_cndmask_b32 v21, v30, 0, vcc
    v_cndmask_b32 v29, 0, 1.0, vcc
    v_cmp_eq_u32 vcc, 0, v16
    v_mov_b32 v30, 320
    s_mov_b32 s3, 0x3acccccd
    v_cndmask_b32 v16, v16, v30, vcc
    v_cvt_f32_u32 v16, v16
    v_cvt_f32_u32 v17, v17
    v_cvt_f32_u32 v18, v18
    v_cvt_f32_u32 v19, v19
    v_cvt_f32_u32 v20, v20
    v_mul_f32 v16, s3, v16
    v_mul_f32 v17, s3, v17
    v_mul_f32 v18, s3, v18
    v_mul_f32 v19, s3, v19
    v_mul_f32 v20, s3, v20
    s_waitcnt lgkmcnt(0)
    v_cos_f32 v24, v16
    v_cos_f32 v25, v17
    s_add_u32 m0, s35, 0
    s_nop 0
    buffer_load_dwordx4 v11, s[4:7], s48 offen offset:0 lds
    v_cos_f32 v26, v18
    v_cos_f32 v27, v19
    v_cos_f32 v28, v20
    s_lshl_b32 s25, s28, 5
    buffer_load_dwordx4 v15, s[4:7], s48 offen offset:1024 lds
    v_lshl_add_u32 v30, v3, 3, s25
    v_cvt_f32_u32 v30, v30
    s_mul_i32 s26, s28, 5120
    v_add_u32 v223, 81920, v4
    s_add_u32 m0, s35, 1408
    s_nop 0
    buffer_load_dwordx4 v11, s[4:7], s48 offen offset:640 lds
    v_add_u32 v31, s26, v223
    v_add_f32 v24, v24, v24
    v_add_f32 v25, v25, v25
    v_add_f32 v26, v26, v26
    buffer_load_dwordx4 v15, s[4:7], s48 offen offset:1664 lds
    v_add_f32 v27, v27, v27
    v_add_f32 v28, v28, v28
    s_add_u32 s62, s8, 5193728
    s_addc_u32 s63, s9, 0
    s_load_dword s34, s[62:63], 0
    v_mul_f32 v32, v30, v16
    v_add_f32 v33, v32, v16
    v_cos_f32 v32, v32
    v_cos_f32 v33, v33
    v_mul_f32 v40, v30, v17
    v_add_f32 v41, v40, v17
    s_add_u32 m0, s35, 3968
    s_nop 0
    buffer_load_dwordx4 v11, s[4:7], s48 offen offset:128 lds
    v_cos_f32 v40, v40
    v_cos_f32 v41, v41
    v_fma_f32 v34, v24, v33, -v32
    v_fma_f32 v35, v24, v34, -v33
    v_fma_f32 v36, v24, v35, -v34
    v_fma_f32 v37, v24, v36, -v35
    v_fma_f32 v38, v24, v37, -v36
    v_fma_f32 v39, v24, v38, -v37
    v_cvt_pk_bf16_f32 v48, v32, v33
    v_cvt_pk_bf16_f32 v49, v34, v35
    v_cvt_pk_bf16_f32 v50, v36, v37
    v_cvt_pk_bf16_f32 v51, v38, v39
    buffer_load_dwordx4 v15, s[4:7], s48 offen offset:1152 lds
    ds_write_b128 v31, v[48:51] offset:0
    v_fma_f32 v32, v30, v18, v21
    v_add_f32 v33, v32, v18
    v_cos_f32 v32, v32
    v_cos_f32 v33, v33
    v_fma_f32 v42, v25, v41, -v40
    v_fma_f32 v43, v25, v42, -v41
    v_fma_f32 v44, v25, v43, -v42
    v_fma_f32 v45, v25, v44, -v43
    v_fma_f32 v46, v25, v45, -v44
    v_fma_f32 v47, v25, v46, -v45
    v_cvt_pk_bf16_f32 v52, v40, v41
    s_add_u32 m0, s35, 5376
    s_nop 0
    buffer_load_dwordx4 v11, s[4:7], s48 offen offset:768 lds
    v_cvt_pk_bf16_f32 v53, v42, v43
    v_cvt_pk_bf16_f32 v54, v44, v45
    v_cvt_pk_bf16_f32 v55, v46, v47
    ds_write_b128 v31, v[52:55] offset:1024
    v_fma_f32 v40, v30, v19, s24
    v_add_f32 v41, v40, v19
    v_cos_f32 v40, v40
    v_cos_f32 v41, v41
    v_fma_f32 v34, v26, v33, -v32
    v_fma_f32 v35, v26, v34, -v33
    v_fma_f32 v36, v26, v35, -v34
    v_fma_f32 v37, v26, v36, -v35
    buffer_load_dwordx4 v15, s[4:7], s48 offen offset:1792 lds
    v_fma_f32 v38, v26, v37, -v36
    v_fma_f32 v39, v26, v38, -v37
    v_cvt_pk_bf16_f32 v48, v32, v33
    v_cvt_pk_bf16_f32 v49, v34, v35
    v_cvt_pk_bf16_f32 v50, v36, v37
    v_cvt_pk_bf16_f32 v51, v38, v39
    ds_write_b128 v31, v[48:51] offset:2048
    v_fma_f32 v32, v30, v20, s24
    v_add_f32 v33, v32, v20
    v_cos_f32 v32, v32
    v_cos_f32 v33, v33
    s_mul_i32 s54, s30, 86
    s_lshr_b32 s54, s54, 8
    s_mul_i32 s54, s54, 3
    s_sub_u32 s54, s30, s54
    s_add_u32 s54, s54, 2
    s_lshl_b32 s49, s54, 12
    s_add_u32 s49, s49, s35
    s_mov_b32 m0, s49
    s_lshl_b32 s27, s54, 7
    s_add_u32 s27, s27, s48
    buffer_load_dwordx4 v11, s[4:7], s27 offen offset:0 lds
    v_fma_f32 v42, v27, v41, -v40
    v_fma_f32 v43, v27, v42, -v41
    v_fma_f32 v44, v27, v43, -v42
    v_fma_f32 v45, v27, v44, -v43
    v_fma_f32 v46, v27, v45, -v44
    v_fma_f32 v47, v27, v46, -v45
    v_cvt_pk_bf16_f32 v52, v40, v41
    v_cvt_pk_bf16_f32 v53, v42, v43
    v_cvt_pk_bf16_f32 v54, v44, v45
    v_cvt_pk_bf16_f32 v55, v46, v47
    ds_write_b128 v31, v[52:55] offset:3072
    s_cmp_eq_u32 s37, 0
    s_cselect_b64 vcc, -1, 0
    v_mov_b32 v14, s24
    v_cndmask_b32 v12, v17, v16, vcc
    v_cndmask_b32 v13, v25, v24, vcc
    v_cndmask_b32 v56, v19, v18, vcc
    v_cndmask_b32 v57, v27, v26, vcc
    v_cndmask_b32 v14, v14, v21, vcc
    buffer_load_dwordx4 v15, s[4:7], s27 offen offset:1024 lds
    s_cmp_lt_u32 s28, 2
    s_cselect_b64 vcc, -1, 0
    s_lshl_b32 s26, s28, 10
    v_cndmask_b32 v12, v56, v12, vcc
    v_cndmask_b32 v13, v57, v13, vcc
    v_cndmask_b32 v14, v14, 0, vcc
    v_add_u32 v58, s26, v223
    v_lshlrev_b32 v30, 3, v3
    v_add_u32 v30, 128, v30
    v_cvt_f32_u32 v30, v30
    v_fma_f32 v40, v30, v12, v14
    v_add_f32 v41, v40, v12
    v_cos_f32 v40, v40
    v_cos_f32 v41, v41
    v_fma_f32 v34, v28, v33, -v32
    v_fma_f32 v35, v28, v34, -v33
    v_fma_f32 v36, v28, v35, -v34
    v_fma_f32 v37, v28, v36, -v35
    s_add_u32 m0, s49, 1408
    s_nop 0
    buffer_load_dwordx4 v11, s[4:7], s27 offen offset:640 lds
    v_fma_f32 v38, v28, v37, -v36
    v_fma_f32 v39, v28, v38, -v37
    v_cvt_pk_bf16_f32 v48, v32, v33
    v_cvt_pk_bf16_f32 v49, v34, v35
    v_cvt_pk_bf16_f32 v50, v36, v37
    v_cvt_pk_bf16_f32 v51, v38, v39
    ds_write_b128 v31, v[48:51] offset:4096
    v_fma_f32 v42, v13, v41, -v40
    v_fma_f32 v43, v13, v42, -v41
    v_fma_f32 v44, v13, v43, -v42
    v_fma_f32 v45, v13, v44, -v43
    v_fma_f32 v46, v13, v45, -v44
    buffer_load_dwordx4 v15, s[4:7], s27 offen offset:1664 lds
    v_fma_f32 v47, v13, v46, -v45
    v_cvt_pk_bf16_f32 v52, v40, v41
    v_cvt_pk_bf16_f32 v53, v42, v43
    v_cvt_pk_bf16_f32 v54, v44, v45
    v_cvt_pk_bf16_f32 v55, v46, v47
    ds_write_b128 v58, v[52:55] offset:20480
    s_cmp_lg_u32 s28, 0
    s_cbranch_scc1 A_gen3
    v_fma_f32 v32, v30, v20, s24
    v_add_f32 v33, v32, v20
    v_cos_f32 v32, v32
    v_cos_f32 v33, v33
    s_nop 0
    v_fma_f32 v34, v28, v33, -v32
    v_fma_f32 v35, v28, v34, -v33
    v_fma_f32 v36, v28, v35, -v34
    v_fma_f32 v37, v28, v36, -v35
    v_fma_f32 v38, v28, v37, -v36
    v_fma_f32 v39, v28, v38, -v37
    v_cvt_pk_bf16_f32 v48, v32, v33
    v_cvt_pk_bf16_f32 v49, v34, v35
    v_cvt_pk_bf16_f32 v50, v36, v37
    v_cvt_pk_bf16_f32 v51, v38, v39
    ds_write_b128 v223, v[48:51] offset:24576
A_gen3:
    v_and_b32 v30, 6, v2
    v_xor_b32 v30, v30, v3
    v_lshlrev_b32 v30, 4, v30
    v_lshl_add_u32 v30, v2, 7, v30
    v_add_u32 v218, s35, v30
    v_xor_b32 v219, 64, v218
    s_cmp_lt_u32 s28, 2
    s_cselect_b32 s12, s44, s46
    s_cselect_b32 s13, s45, s47
    s_mov_b32 s16, s40
    s_mov_b32 s17, s41
    s_mov_b32 s20, s42
    s_mov_b32 s21, s43
    s_mov_b32 s3, 0x3f803f80
    v_mov_b32 v144, s3
    v_mov_b32 v145, s3
    v_mov_b32 v146, s3
    v_mov_b32 v147, s3
    v_mov_b32 v222, 1.0
    v_cmp_eq_u32 s[56:57], 0, v3
    s_mov_b32 s10, 14942208
    s_mov_b32 s11, 0x20000
    s_mov_b32 s14, 1966080
    s_mov_b32 s15, 0x20000
    s_mov_b32 s18, 1966080
    s_mov_b32 s19, 0x20000
    s_mov_b32 s22, 2621440
    s_mov_b32 s23, 0x20000
    s_mov_b32 s38, 0
    s_bfe_u32 s32, s2, 0x10002
    s_lshl_b32 s32, s32, 3
    s_lshr_b32 s3, s2, 5
    s_add_u32 s32, s32, s3
    s_and_b32 s33, s2, 3
    s_lshl_b32 s33, s33, 2
    s_and_b32 s3, s30, 3
    s_add_u32 s33, s33, s3
    s_add_u32 s36, s35, 81920
    s_waitcnt lgkmcnt(0)
    s_barrier
    ds_read_b128 a[0:3], v223 offset:0
    ds_read_b128 a[4:7], v223 offset:1024
    ds_read_b128 a[8:11], v223 offset:2048
    ds_read_b128 a[12:15], v223 offset:3072
    ds_read_b128 a[16:19], v223 offset:4096
    ds_read_b128 a[20:23], v223 offset:5120
    ds_read_b128 a[24:27], v223 offset:6144
    ds_read_b128 a[28:31], v223 offset:7168
    ds_read_b128 a[32:35], v223 offset:8192
    ds_read_b128 a[36:39], v223 offset:9216
    s_waitcnt vmcnt(8)
    ds_read_b128 v[64:67], v218 offset:0
    ds_read_b128 v[68:71], v218 offset:2048
    ds_read_b128 v[72:75], v219 offset:0
    ds_read_b128 v[76:79], v219 offset:2048
    s_add_u32 s54, s54, 1
    s_cmp_eq_u32 s54, 5
    s_cselect_b32 s54, 2, s54
    s_lshl_b32 s49, s54, 12
    s_add_u32 s49, s49, s35
    s_mov_b32 m0, s49
    s_lshl_b32 s27, s54, 7
    s_add_u32 s27, s27, s48
    buffer_load_dwordx4 v11, s[4:7], s27 offen offset:0 lds
    buffer_load_dwordx4 v15, s[4:7], s27 offen offset:1024 lds
    s_add_u32 m0, s49, 1408
    s_nop 0
    buffer_load_dwordx4 v11, s[4:7], s27 offen offset:640 lds
    buffer_load_dwordx4 v15, s[4:7], s27 offen offset:1664 lds
    s_waitcnt lgkmcnt(0)
    v_mfma_f32_16x16x32_bf16 v[140:143], v[64:67], v[64:67], 0
    s_add_u32 s54, s54, 1
    s_cmp_eq_u32 s54, 5
    v_mfma_f32_16x16x32_bf16 v[140:143], v[68:71], v[68:71], v[140:143]
    s_cselect_b32 s54, 2, s54
    s_lshl_b32 s49, s54, 12
    s_add_u32 s49, s49, s35
    v_mfma_f32_16x16x32_bf16 v[140:143], v[72:75], v[72:75], v[140:143]
    s_mov_b32 m0, s49
    s_lshl_b32 s27, s54, 7
    s_add_u32 s27, s27, s48
    v_mfma_f32_16x16x32_bf16 v[140:143], v[76:79], v[76:79], v[140:143]
    v_lshlrev_b32 v22, 16, v64
    v_cndmask_b32 v22, 0, v22, s[56:57]
    buffer_load_dwordx4 v11, s[4:7], s27 offen offset:0 lds
    v_mfma_f32_16x16x32_bf16 v[136:139], v[64:67], v[144:147], 0
    v_cmp_gt_u32 vcc, 8, v2
    v_mov_b32 v30, 2176
    v_mov_b32 v31, 2944
    v_cndmask_b32 v60, v31, v30, vcc
    v_cndmask_b32 v62, v30, v31, vcc
    v_sub_u32 v31, 0, v30
    v_cndmask_b32 v61, v31, v30, vcc
    v_and_b32 v30, 1, v2
    v_mad_i32_i24 v60, v60, v30, v223
    v_mad_i32_i24 v61, v61, v30, v223
    v_mul_u32_u24 v62, v62, v30
    v_sub_u32 v62, v223, v62
    v_mfma_f32_16x16x32_bf16 v[136:139], v[68:71], v[144:147], v[136:139]
    ds_read_b128 a[40:43], v223 offset:10240
    ds_read_b128 a[44:47], v223 offset:11264
    v_mfma_f32_16x16x32_bf16 v[136:139], v[72:75], v[144:147], v[136:139]
    ds_read_b128 a[48:51], v223 offset:12288
    s_lshl_b32 s3, s28, 8
    v_mfma_f32_16x16x32_bf16 v[136:139], v[76:79], v[144:147], v[136:139]
    buffer_load_dwordx4 v15, s[4:7], s27 offen offset:1024 lds
    s_add_u32 s3, s3, s29
    v_mfma_f32_16x16x32_bf16 v[96:99], v[64:67], a[0:3], 0
    v_mfma_f32_16x16x4_f32 v[248:251], v22, v222, 0
    s_mul_i32 s58, s3, 1664
    v_mfma_f32_16x16x32_bf16 v[116:119], v[68:71], a[0:3], 0
    s_mul_i32 s3, s30, 192
    s_add_u32 s58, s58, s3
    s_add_u32 s59, s58, 53248
    v_mfma_f32_16x16x32_bf16 v[100:103], v[64:67], a[4:7], 0
    ds_read_b128 a[52:55], v223 offset:13312
    ds_read_b128 a[56:59], v223 offset:14336
    ds_read_b128 a[60:63], v223 offset:15360
    ds_read_b128 a[64:67], v223 offset:16384
    ds_read_b128 a[68:71], v223 offset:17408
    ds_read_b128 a[72:75], v223 offset:18432
    ds_read_b128 a[76:79], v223 offset:19456
    v_mfma_f32_16x16x32_bf16 v[120:123], v[68:71], a[4:7], 0
    s_add_u32 m0, s49, 1408
    v_mul_u32_u24 v220, 106496, v3
    buffer_load_dwordx4 v11, s[4:7], s27 offen offset:640 lds
    v_mfma_f32_16x16x32_bf16 v[104:107], v[64:67], a[8:11], 0
    v_lshl_add_u32 v220, v2, 4, v220
    v_mov_b32 v175, 1073741824
    s_cmp_eq_u32 s30, 7
    v_mfma_f32_16x16x32_bf16 v[124:127], v[68:71], a[8:11], 0
    s_cselect_b32 s3, 12, 12
    v_cmp_gt_u32 vcc, s3, v2
    v_lshlrev_b32 v221, 4, v3
    v_mfma_f32_16x16x32_bf16 v[108:111], v[64:67], a[12:15], 0
    v_add_u32 v215, s30, v2
    v_cndmask_b32 v220, v175, v220, vcc
    v_cmp_eq_u32 vcc, 0, v215
    v_mfma_f32_16x16x32_bf16 v[128:131], v[68:71], a[12:15], 0
    s_waitcnt vmcnt(11)
    ds_read_b128 v[80:83], v218 offset:4096
    ds_read_b128 v[84:87], v218 offset:6144
    ds_read_b128 v[88:91], v219 offset:4096
    ds_read_b128 v[92:95], v219 offset:6144
    v_mfma_f32_16x16x32_bf16 v[112:115], v[64:67], a[16:19], 0
    buffer_load_dwordx4 v15, s[4:7], s27 offen offset:1664 lds
    s_lshl_b32 s3, s29, 8
    v_mfma_f32_16x16x32_bf16 v[132:135], v[68:71], a[16:19], 0
    s_lshl_b32 s60, s28, 6
    s_add_u32 s60, s60, s3
    s_add_u32 s60, s60, 2228224
    v_mfma_f32_16x16x32_bf16 v[96:99], v[72:75], a[20:23], v[96:99]
    v_cndmask_b32 v221, v175, v221, vcc
    v_mov_b32 v16, -1
    v_mov_b32 v17, -1
    v_mfma_f32_16x16x32_bf16 v[116:119], v[76:79], a[20:23], v[116:119]
    v_mov_b32 v18, -1
    v_mov_b32 v19, -1
    s_cmp_eq_u32 s28, 0
    v_mfma_f32_16x16x32_bf16 v[100:103], v[72:75], a[24:27], v[100:103]
    s_cselect_b32 s55, 0, 1073741824
    s_lshl3_add_u32 s61, s28, s30
    s_cmp_ge_u32 s61, 20
    v_mfma_f32_16x16x32_bf16 v[120:123], v[76:79], a[24:27], v[120:123]
    s_cselect_b32 s3, 1073741824, 0
    v_add_u32 v20, s3, v4
    v_lshl_add_u32 v21, v1, 2, s55
    v_mfma_f32_16x16x32_bf16 v[104:107], v[72:75], a[28:31], v[104:107]
    s_and_b32 s3, s29, 1
    s_lshr_b32 s73, s29, 1
    s_lshl4_add_u32 s3, s3, s73
    v_mfma_f32_16x16x32_bf16 v[124:127], v[76:79], a[28:31], v[124:127]
    s_mul_i32 s3, s3, 20
    s_add_u32 s3, s3, s61
    s_lshl_b32 s3, s3, 10
    s_add_u32 s73, s3, 2400256
    s_lshl3_add_u32 s3, s29, s30
    s_lshl_b32 s3, s3, 8
    s_add_u32 s76, s3, 2236416
    s_lshl4_add_u32 s3, s32, s33
    s_lshl_b32 s3, s3, 9
    s_add_u32 s3, s3, 5062528
    v_lshl_add_u32 v28, v2, 2, s3
    v_lshl_add_u32 v28, v3, 7, v28
    s_lshl4_add_u32 s3, s2, 5046272
    v_bfi_b32 v30, 12, v28, s3
    v_cndmask_b32 v28, v28, v30, s[56:57]
    v_add_u32 v28, s55, v28
    v_mfma_f32_16x16x32_bf16 v[108:111], v[72:75], a[32:35], v[108:111]
    v_lshrrev_b32 v5, 3, v1
    v_mul_u32_u24 v5, 3072, v5
    v_mfma_f32_16x16x32_bf16 v[128:131], v[76:79], a[32:35], v[128:131]
    v_and_b32 v30, 1, v3
    v_lshlrev_b32 v30, 1, v30
    v_mfma_f32_16x16x32_bf16 v[112:115], v[72:75], a[36:39], v[112:115]
    v_and_b32 v31, 7, v1
    v_xor_b32 v30, v30, v31
    v_mfma_f32_16x16x32_bf16 v[132:135], v[76:79], a[36:39], v[132:135]
    v_lshl_add_u32 v5, v30, 4, v5
    s_waitcnt lgkmcnt(0)
    v_mfma_f32_16x16x32_bf16 v[140:143], v[80:83], v[80:83], v[140:143]
    v_xor_b32 v6, 64, v5
    v_add_u32 v6, 23552, v6
    v_mfma_f32_16x16x32_bf16 v[140:143], v[84:87], v[84:87], v[140:143]
    s_mul_i32 s39, s37, 49152
    s_sub_u32 s0, s2, 96
    v_mfma_f32_16x16x32_bf16 v[140:143], v[88:91], v[88:91], v[140:143]
    s_cselect_b32 s0, 0, s0
    s_cselect_b32 s46, 1073741824, 0
    s_mul_i32 s1, s0, 3277
    v_mfma_f32_16x16x32_bf16 v[140:143], v[92:95], v[92:95], v[140:143]
    s_lshr_b32 s1, s1, 16
    s_mul_i32 s3, s1, 20
    v_mfma_f32_16x16x32_bf16 v[136:139], v[80:83], v[144:147], v[136:139]
    s_sub_u32 s0, s0, s3
    s_mul_i32 s44, s0, 98304
    s_mul_i32 s3, s1, 384
    v_mfma_f32_16x16x32_bf16 v[136:139], v[84:87], v[144:147], v[136:139]
    s_add_u32 s44, s44, s3
    s_add_u32 s44, s44, s39
    s_add_u32 s44, s44, 128
    v_mfma_f32_16x16x32_bf16 v[136:139], v[88:91], v[144:147], v[136:139]
    s_lshl3_add_u32 s3, s1, s28
    s_mul_i32 s3, s3, 20
    ds_read_b128 a[0:3], v223 offset:20480
    v_mfma_f32_16x16x32_bf16 v[136:139], v[92:95], v[144:147], v[136:139]
    buffer_store_dword v16, v28, s[8:11], 0 offen sc1
    s_add_u32 s3, s3, s0
    v_mfma_f32_16x16x32_bf16 v[96:99], v[80:83], a[40:43], v[96:99]
    buffer_store_dwordx4 v[16:19], v220, s[8:11], s58 offen sc1
    s_lshl_b32 s3, s3, 10
    v_mfma_f32_16x16x32_bf16 v[116:119], v[84:87], a[40:43], v[116:119]
    s_add_u32 s45, s3, 13631488
    ds_read_b128 a[4:7], v223 offset:21504
    ds_read_b128 a[8:11], v223 offset:22528
    v_mfma_f32_16x16x32_bf16 v[100:103], v[80:83], a[44:47], v[100:103]
    ds_read_b128 a[12:15], v223 offset:23552
    ds_read_b128 a[16:19], v223 offset:24576
    ds_read_b128 a[20:23], v60 offset:0
    ds_read_b128 a[24:27], v60 offset:1024
    ds_read_b128 a[28:31], v61 offset:2048
    ds_read_b128 a[32:35], v62 offset:3072
    ds_read_b128 a[36:39], v62 offset:4096
    v_mfma_f32_16x16x32_bf16 v[120:123], v[84:87], a[44:47], v[120:123]
    s_mul_i32 s3, s33, 192
    s_add_u32 s39, s39, s3
    s_and_b32 s3, s33, 1
    v_mfma_f32_16x16x32_bf16 v[104:107], v[80:83], a[48:51], v[104:107]
    buffer_store_dwordx4 v[16:19], v220, s[8:11], s59 offen sc1
    s_lshl_b32 s3, s3, 6
    v_mfma_f32_16x16x32_bf16 v[124:127], v[84:87], a[48:51], v[124:127]
    s_add_u32 s39, s39, s3
    s_add_u32 s62, s39, 1966080
    s_lshr_b32 s63, s2, 5
    v_mfma_f32_16x16x32_bf16 v[108:111], v[80:83], a[52:55], v[108:111]
    s_mul_i32 s63, s63, 5
    s_lshr_b32 s63, s63, 1
    s_mul_i32 s3, s63, 98304
    v_mfma_f32_16x16x32_bf16 v[128:131], v[84:87], a[52:55], v[128:131]
    buffer_store_dwordx4 v[16:19], v221, s[8:11], s60 offen sc1
    s_add_u32 s47, s39, s3
    v_mfma_f32_16x16x32_bf16 v[112:115], v[80:83], a[56:59], v[112:115]
    buffer_store_dwordx4 v[16:19], v20, s[8:11], s73 offen sc1
    s_mul_i32 s40, s2, 13108
    v_mfma_f32_16x16x32_bf16 v[132:135], v[84:87], a[56:59], v[132:135]
    s_lshr_b32 s40, s40, 16
    s_mul_i32 s3, s40, 5
    s_sub_u32 s41, s2, s3
    v_mfma_f32_16x16x32_bf16 v[96:99], v[88:91], a[60:63], v[96:99]
    s_cmp_lt_u32 s2, 240
    s_cselect_b32 s42, 0, 1073741824
    s_mul_i32 s43, s40, 21846
    v_mfma_f32_16x16x32_bf16 v[116:119], v[92:95], a[60:63], v[116:119]
    s_lshr_b32 s43, s43, 16
    s_mul_i32 s3, s43, 3
    s_sub_u32 s40, s40, s3
    v_mfma_f32_16x16x32_bf16 v[100:103], v[88:91], a[64:67], v[100:103]
    buffer_store_dword v16, v21, s[8:11], s76 offen sc1
    s_and_b32 s3, s43, 1
    v_mfma_f32_16x16x32_bf16 v[120:123], v[92:95], a[64:67], v[120:123]
    s_lshl3_add_u32 s0, s3, s28
    s_lshl_b32 s0, s0, 4
    s_lshl2_add_u32 s1, s3, s28
    v_mfma_f32_16x16x32_bf16 v[104:107], v[88:91], a[68:71], v[104:107]
    s_lshl3_add_u32 s1, s1, 64
    s_lshl1_add_u32 s1, s40, s1
    s_lshl1_add_u32 s0, s40, s0
    v_mfma_f32_16x16x32_bf16 v[124:127], v[92:95], a[68:71], v[124:127]
    s_add_u32 s3, s0, 10
    s_cmp_eq_u32 s40, 2
    s_cselect_b32 s3, s1, s3
    v_mfma_f32_16x16x32_bf16 v[108:111], v[88:91], a[72:75], v[108:111]
    s_lshl_b32 s3, s3, 8
    s_add_u32 s3, s3, s1
    s_lshl_b32 s3, s3, 16
    v_mfma_f32_16x16x32_bf16 v[128:131], v[92:95], a[72:75], v[128:131]
    s_lshl1_add_u32 s0, s40, s0
    s_mul_i32 s0, s0, 257
    s_add_u32 s0, s0, s3
    s_add_u32 s0, s0, 0x02000200
    v_lshlrev_b32 v30, 3, v3
    v_bfe_u32 v30, s0, v30, 8
    v_bfe_u32 v31, v1, 3, 1
    v_add_u32 v30, v30, v31
    v_mul_u32_u24 v227, 1280, v30
    v_and_b32 v30, 7, v1
    v_lshl_add_u32 v227, v30, 4, v227
    v_add_u32 v227, s42, v227
    s_lshr_b32 s43, s43, 1
    s_mul_i32 s43, s43, 245760
    s_lshl_b32 s3, s41, 8
    s_add_u32 s43, s43, s3
    s_lshl_b32 s40, s28, 11
    s_add_u32 s40, s40, 147456
    v_mfma_f32_16x16x32_bf16 v[112:115], v[88:91], a[76:79], v[112:115]
    s_waitcnt vmcnt(6)
    ds_read_b128 v[64:67], v218 offset:8192
    v_mfma_f32_16x16x32_bf16 v[132:135], v[92:95], a[76:79], v[132:135]
    ds_read_b128 v[68:71], v218 offset:10240
    ds_read_b128 v[72:75], v219 offset:8192
    ds_read_b128 v[76:79], v219 offset:10240
    s_waitcnt lgkmcnt(0)
    v_mfma_f32_16x16x32_bf16 v[140:143], v[64:67], v[64:67], v[140:143]
    s_lshl_b32 s3, s28, 3
    v_lshrrev_b32 v164, 1, v2
    v_add_u32 v164, s3, v164
    v_mfma_f32_16x16x32_bf16 v[140:143], v[68:71], v[68:71], v[140:143]
    v_and_b32 v165, 1, v2
    v_lshlrev_b32 v166, 9, v3
    v_add_u32 v167, s31, v166
    v_mfma_f32_16x16x32_bf16 v[140:143], v[72:75], v[72:75], v[140:143]
    v_add_u32 v166, s29, v166
    v_mul_u32_u24 v166, v166, v164
    v_mfma_f32_16x16x32_bf16 v[140:143], v[76:79], v[76:79], v[140:143]
    v_mul_u32_u24 v167, v167, v164
    v_cvt_f32_u32 v166, v166
    v_cvt_f32_u32 v167, v167
    v_mfma_f32_16x16x32_bf16 v[136:139], v[64:67], v[144:147], v[136:139]
    v_cvt_f32_u32 v168, v164
    v_cvt_f32_u32 v169, v165
    v_mul_f32 v168, 0x3d000000, v168
    v_mfma_f32_16x16x32_bf16 v[136:139], v[68:71], v[144:147], v[136:139]
    ds_read_b128 a[40:43], v60 offset:5120
    ds_read_b128 a[44:47], v60 offset:6144
    v_cos_f32 v170, v168
    v_mfma_f32_16x16x32_bf16 v[136:139], v[72:75], v[144:147], v[136:139]
    s_cmp_eq_u32 s29, 0
    s_cselect_b32 s64, 0, s24
    s_cselect_b32 s65, 1.0, 0
    v_mfma_f32_16x16x32_bf16 v[136:139], v[76:79], v[144:147], v[136:139]
    ds_read_b128 a[48:51], v61 offset:7168
    v_mul_f32 v171, s64, v169
    ds_read_b128 a[52:55], v62 offset:8192
    v_mfma_f32_16x16x32_bf16 v[96:99], v[64:67], a[0:3], v[96:99]
    s_mov_b32 s66, 0x3a000000
    v_fma_f32 v176, v166, s66, -v171
    ds_read_b128 a[56:59], v62 offset:9216
    v_mfma_f32_16x16x32_bf16 v[116:119], v[68:71], a[0:3], v[116:119]
    s_mov_b32 m0, s40
    v_fma_f32 v184, v167, s66, v171
    v_add_f32 v170, v170, v170
    v_mfma_f32_16x16x32_bf16 v[100:103], v[64:67], a[4:7], v[100:103]
    ds_read_b128 a[60:63], v60 offset:10240
    ds_read_b128 a[64:67], v60 offset:11264
    ds_read_b128 a[68:71], v61 offset:12288
    ds_read_b128 a[72:75], v62 offset:13312
    ds_read_b128 a[76:79], v62 offset:14336
    v_mfma_f32_16x16x32_bf16 v[120:123], v[68:71], a[4:7], v[120:123]
    buffer_load_dwordx4 v5, s[12:15], s44 offen lds
    v_fma_f32 v172, -v169, s65, 1.0
    v_mfma_f32_16x16x32_bf16 v[104:107], v[64:67], a[8:11], v[104:107]
    v_subrev_f32 v216, 1.0, v169
    v_fma_f32 v173, v216, s65, 1.0
    v_add_f32 v177, v176, v168
    v_mfma_f32_16x16x32_bf16 v[124:127], v[68:71], a[8:11], v[124:127]
    v_add_f32 v185, v184, v168
    ds_read_b128 v[80:83], v218 offset:12288
    v_sin_f32 v192, v176
    v_mfma_f32_16x16x32_bf16 v[108:111], v[64:67], a[12:15], v[108:111]
    buffer_load_dwordx4 v6, s[12:15], s44 offen offset:1024 lds
    v_cos_f32 v176, v176
    v_mfma_f32_16x16x32_bf16 v[128:131], v[68:71], a[12:15], v[128:131]
    ds_read_b128 v[84:87], v218 offset:14336
    ds_read_b128 v[88:91], v219 offset:12288
    ds_read_b128 v[92:95], v219 offset:14336
    v_mfma_f32_16x16x32_bf16 v[112:115], v[64:67], a[16:19], v[112:115]
    v_sin_f32 v200, v184
    v_cos_f32 v184, v184
    v_mfma_f32_16x16x32_bf16 v[132:135], v[68:71], a[16:19], v[132:135]
    s_add_u32 m0, s40, 8192
    v_mul_f32 v192, v192, v172
    v_sin_f32 v193, v177
    v_mfma_f32_16x16x32_bf16 v[228:231], v[72:75], a[20:23], 0
    buffer_load_dwordx4 v227, s[16:19], s43 offen offset:0 lds
    v_cos_f32 v177, v177
    v_mfma_f32_16x16x32_bf16 v[32:35], v[76:79], a[20:23], 0
    v_sin_f32 v201, v185
    v_cos_f32 v185, v185
    v_mfma_f32_16x16x32_bf16 v[232:235], v[72:75], a[24:27], 0
    s_add_u32 m0, s40, 9088
    v_mul_f32 v200, v200, v173
    v_mul_f32 v176, v176, v172
    v_mfma_f32_16x16x32_bf16 v[36:39], v[76:79], a[24:27], 0
    buffer_load_dwordx4 v227, s[16:19], s43 offen offset:128 lds
    v_mul_f32 v184, v184, v173
    v_mfma_f32_16x16x32_bf16 v[236:239], v[72:75], a[28:31], 0
    v_mul_f32 v193, v193, v172
    v_mul_f32 v201, v201, v173
    v_mul_f32 v177, v177, v172
    v_mfma_f32_16x16x32_bf16 v[40:43], v[76:79], a[28:31], 0
    v_mul_f32 v185, v185, v173
    v_fma_f32 v178, v170, v177, -v176
    v_fma_f32 v186, v170, v185, -v184
    v_mfma_f32_16x16x32_bf16 v[240:243], v[72:75], a[32:35], 0
    v_fma_f32 v194, v170, v193, -v192
    v_fma_f32 v202, v170, v201, -v200
    v_fma_f32 v179, v170, v178, -v177
    v_mfma_f32_16x16x32_bf16 v[44:47], v[76:79], a[32:35], 0
    v_fma_f32 v187, v170, v186, -v185
    v_fma_f32 v195, v170, v194, -v193
    v_fma_f32 v203, v170, v202, -v201
    v_mfma_f32_16x16x32_bf16 v[244:247], v[72:75], a[36:39], 0
    v_fma_f32 v180, v170, v179, -v178
    v_fma_f32 v188, v170, v187, -v186
    v_fma_f32 v196, v170, v195, -v194
    v_mfma_f32_16x16x32_bf16 v[48:51], v[76:79], a[36:39], 0
    v_fma_f32 v204, v170, v203, -v202
    v_fma_f32 v181, v170, v180, -v179
    s_waitcnt lgkmcnt(0)
    v_mfma_f32_16x16x32_bf16 v[140:143], v[80:83], v[80:83], v[140:143]
    v_fma_f32 v189, v170, v188, -v187
    v_fma_f32 v197, v170, v196, -v195
    v_fma_f32 v205, v170, v204, -v203
    v_mfma_f32_16x16x32_bf16 v[140:143], v[84:87], v[84:87], v[140:143]
    v_fma_f32 v182, v170, v181, -v180
    v_fma_f32 v190, v170, v189, -v188
    v_fma_f32 v198, v170, v197, -v196
    v_mfma_f32_16x16x32_bf16 v[140:143], v[88:91], v[88:91], v[140:143]
    v_fma_f32 v206, v170, v205, -v204
    v_fma_f32 v183, v170, v182, -v181
    v_fma_f32 v191, v170, v190, -v189
    v_mfma_f32_16x16x32_bf16 v[140:143], v[92:95], v[92:95], v[140:143]
    v_fma_f32 v199, v170, v198, -v197
    v_fma_f32 v207, v170, v206, -v205
    v_cvt_pk_bf16_f32 v148, v176, v177
    v_mfma_f32_16x16x32_bf16 v[136:139], v[80:83], v[144:147], v[136:139]
    v_cvt_pk_bf16_f32 v149, v178, v179
    v_cvt_pk_bf16_f32 v150, v180, v181
    v_cvt_pk_bf16_f32 v151, v182, v183
    v_mfma_f32_16x16x32_bf16 v[136:139], v[84:87], v[144:147], v[136:139]
    v_cvt_pk_bf16_f32 v152, v184, v185
    v_cvt_pk_bf16_f32 v153, v186, v187
    v_cvt_pk_bf16_f32 v154, v188, v189
    v_mfma_f32_16x16x32_bf16 v[136:139], v[88:91], v[144:147], v[136:139]
    v_cvt_pk_bf16_f32 v155, v190, v191
    v_cvt_pk_bf16_f32 v156, v192, v193
    v_cvt_pk_bf16_f32 v157, v194, v195
    v_mfma_f32_16x16x32_bf16 v[136:139], v[92:95], v[144:147], v[136:139]
    v_cvt_pk_bf16_f32 v158, v196, v197
    ds_read_b128 a[0:3], v60 offset:15360
    v_cvt_pk_bf16_f32 v159, v198, v199
    v_mfma_f32_16x16x32_bf16 v[228:231], v[80:83], a[40:43], v[228:231]
    v_cvt_pk_bf16_f32 v160, v200, v201
    v_cvt_pk_bf16_f32 v161, v202, v203
    ds_read_b128 a[4:7], v60 offset:16384
    v_mfma_f32_16x16x32_bf16 v[32:35], v[84:87], a[40:43], v[32:35]
    v_cvt_pk_bf16_f32 v162, v204, v205
    v_cvt_pk_bf16_f32 v163, v206, v207
    ds_read_b128 a[8:11], v61 offset:17408
    v_mfma_f32_16x16x32_bf16 v[232:235], v[80:83], a[44:47], v[232:235]
    ds_read_b128 a[12:15], v62 offset:18432
    ds_read_b128 a[16:19], v62 offset:19456
    ds_read_b128 a[20:23], v60 offset:20480
    ds_read_b128 a[24:27], v60 offset:21504
    ds_read_b128 a[28:31], v61 offset:22528
    ds_read_b128 a[32:35], v62 offset:23552
    ds_read_b128 a[36:39], v62 offset:24576
    v_mfma_f32_16x16x32_bf16 v[36:39], v[84:87], a[44:47], v[36:39]
    v_cmp_gt_u32 vcc, 8, v2
    v_and_b32 v30, 3, v2
    v_lshrrev_b32 v31, 2, v2
    v_mfma_f32_16x16x32_bf16 v[236:239], v[80:83], a[48:51], v[236:239]
    v_mad_u32_u24 v30, v30, 11, v31
    v_mul_u32_u24 v30, 288, v30
    s_lshl_b32 s3, s28, 5
    v_mfma_f32_16x16x32_bf16 v[40:43], v[84:87], a[48:51], v[40:43]
    s_add_u32 s3, s3, 133120
    v_lshl_add_u32 v174, v3, 3, s3
    v_add_u32 v208, v30, v174
    v_mfma_f32_16x16x32_bf16 v[240:243], v[80:83], a[52:55], v[240:243]
    v_subrev_u32 v30, 2752, v208
    v_cndmask_b32 v209, v30, v208, vcc
    v_lshl_add_u32 v213, v165, 7, v174
    v_mfma_f32_16x16x32_bf16 v[44:47], v[84:87], a[52:55], v[44:47]
    ds_read_b128 v[64:67], v218 offset:16384
    ds_read_b128 v[68:71], v218 offset:18432
    ds_read_b128 v[72:75], v219 offset:16384
    ds_read_b128 v[76:79], v219 offset:18432
    v_mfma_f32_16x16x32_bf16 v[244:247], v[80:83], a[56:59], v[244:247]
    v_fma_f32 v214, v169, -2.0, 1.0
    v_mul_u32_u24 v217, 288, v2
    v_lshl_add_u32 v217, v3, 4, v217
    v_mfma_f32_16x16x32_bf16 v[48:51], v[84:87], a[56:59], v[48:51]
    v_add_u32 v217, 133120, v217
    v_lshlrev_b32 v215, 2, v3
    v_sub_u32 v215, v2, v215
    v_mfma_f32_16x16x32_bf16 v[228:231], v[88:91], a[60:63], v[228:231]
    v_lshrrev_b32 v30, 2, v2
    v_lshlrev_b32 v8, 7, v30
    v_and_b32 v31, 3, v2
    v_mfma_f32_16x16x32_bf16 v[32:35], v[92:95], a[60:63], v[32:35]
    v_lshl_add_u32 v25, v31, 3, v8
    v_lshl_add_u32 v25, v3, 11, v25
    s_lshl_b32 s3, s28, 5
    v_mfma_f32_16x16x32_bf16 v[232:235], v[88:91], a[64:67], v[232:235]
    s_add_u32 s3, s3, 155648
    v_add_u32 v25, s3, v25
    v_and_b32 v30, 2, v30
    v_mfma_f32_16x16x32_bf16 v[36:39], v[92:95], a[64:67], v[36:39]
    v_and_b32 v31, 1, v3
    v_lshl_add_u32 v8, v31, 10, v8
    v_lshl_add_u32 v30, v31, 2, v30
    v_mfma_f32_16x16x32_bf16 v[236:239], v[88:91], a[68:71], v[236:239]
    v_and_b32 v31, 1, v2
    v_lshl_add_u32 v8, v31, 3, v8
    v_xor_b32 v7, s28, v30
    v_mfma_f32_16x16x32_bf16 v[40:43], v[92:95], a[68:71], v[40:43]
    v_lshl_add_u32 v7, v7, 4, v8
    v_and_b32 v9, 2, v2
    v_lshrrev_b32 v10, 1, v3
    v_mfma_f32_16x16x32_bf16 v[240:243], v[88:91], a[72:75], v[240:243]
    v_add_u32 v9, v9, v10
    v_lshl_add_u32 v7, v9, 11, v7
    v_add_u32 v7, 147456, v7
    v_mfma_f32_16x16x32_bf16 v[44:47], v[92:95], a[72:75], v[44:47]
    v_mul_u32_u24 v10, 20480, v10
    v_add_u32 v8, v8, v10
    v_bfe_u32 v9, v2, 1, 1
    v_mfma_f32_16x16x32_bf16 v[244:247], v[88:91], a[76:79], v[244:247]
    v_lshl_add_u32 v9, s28, 1, v9
    v_xor_b32 v9, v9, v30
    v_lshl_add_u32 v8, v9, 4, v8
    v_add_u32 v9, 81920, v8
    v_xor_b32 v10, 64, v7
    v_and_b32 v30, 6, v2
    v_lshl_add_u32 v30, v30, 1, v31
    v_lshrrev_b32 v31, 3, v2
    v_lshl_add_u32 v30, v31, 1, v30
    v_lshlrev_b32 v212, 8, v3
    v_lshl_add_u32 v212, v30, 4, v212
    v_add_u32 v212, s46, v212
    s_lshl3_add_u32 s3, s2, s28
    s_lshl_b32 s3, s3, 10
    s_add_u32 s0, s3, 5242880
    s_add_u32 s1, s0, 4096
    v_add_u32 v226, s42, v4
    v_mfma_f32_16x16x32_bf16 v[48:51], v[92:95], a[76:79], v[48:51]
    v_cmp_eq_u32 s[24:25], 0, v215
    s_waitcnt lgkmcnt(0)
    v_mfma_f32_16x16x32_bf16 v[140:143], v[64:67], v[64:67], v[140:143]
    v_cmp_eq_u32 s[50:51], 1, v215
    v_cmp_eq_u32 s[52:53], 2, v215
    v_mfma_f32_16x16x32_bf16 v[140:143], v[68:71], v[68:71], v[140:143]
    v_cmp_eq_u32 s[26:27], 3, v215
    v_mov_b32 v215, v214
    v_mfma_f32_16x16x32_bf16 v[140:143], v[72:75], v[72:75], v[140:143]
    v_and_b32 v30, 2, v2
    v_cvt_f32_u32 v30, v30
    v_mfma_f32_16x16x32_bf16 v[140:143], v[76:79], v[76:79], v[140:143]
    v_sub_f32 v26, 1.0, v30
    v_fma_f32 v31, v29, 2.0, v214
    v_mfma_f32_16x16x32_bf16 v[136:139], v[64:67], v[144:147], v[136:139]
    v_min_f32 v31, 1.0, v31
    v_mul_f32 v27, v26, v31
    v_mfma_f32_16x16x32_bf16 v[136:139], v[68:71], v[144:147], v[136:139]
    s_mul_i32 s34, s34, 1664525
    s_add_u32 s34, s34, 1013904223
    v_mfma_f32_16x16x32_bf16 v[136:139], v[72:75], v[144:147], v[136:139]
    s_lshl_b32 s3, s2, 4
    s_add_u32 s3, s3, s55
    s_add_u32 s3, s3, 5029888
    v_lshrrev_b32 v225, 4, v1
    v_lshl_add_u32 v225, v225, 2, s3
    v_mov_b32 v23, s34
    v_mfma_f32_16x16x32_bf16 v[136:139], v[76:79], v[144:147], v[136:139]
    s_add_u32 m0, s35, 0
    v_cndmask_b32 v30, 0, v140, s[24:25]
    buffer_load_dwordx4 v5, s[12:15], s47 offen offset:0 lds
    v_mfma_f32_16x16x32_bf16 v[228:231], v[64:67], a[0:3], v[228:231]
    v_cndmask_b32 v30, v30, v141, s[50:51]
    v_cndmask_b32 v30, v30, v142, s[52:53]
    v_mfma_f32_16x16x32_bf16 v[32:35], v[68:71], a[0:3], v[32:35]
    v_cndmask_b32 v30, v30, v143, s[26:27]
    v_mov_b32 v31, 0x3acccccd
    v_mfma_f32_16x16x32_bf16 v[232:235], v[64:67], a[4:7], v[232:235]
    buffer_load_dwordx4 v6, s[12:15], s47 offen offset:1024 lds
    v_mfma_f32_16x16x32_bf16 v[36:39], v[68:71], a[4:7], v[36:39]
    v_mov_b32 v24, 0x3727c5ac
    v_mfma_f32_16x16x32_bf16 v[236:239], v[64:67], a[8:11], v[236:239]
    v_mfma_f32_16x16x4_f32 v[56:59], v30, v222, 0
    v_mfma_f32_16x16x32_bf16 v[40:43], v[68:71], a[8:11], v[40:43]
    v_mul_f32 v136, v31, v136
    v_mul_f32 v137, v31, v137
    v_mfma_f32_16x16x32_bf16 v[240:243], v[64:67], a[12:15], v[240:243]
    s_add_u32 m0, s35, 2048
    s_add_u32 s47, s47, 98304
    v_mfma_f32_16x16x32_bf16 v[44:47], v[68:71], a[12:15], v[44:47]
    s_cmp_eq_u32 s47, s62
    s_cselect_b32 s47, s39, s47
    buffer_load_dwordx4 v5, s[12:15], s47 offen offset:0 lds
    v_mfma_f32_16x16x32_bf16 v[244:247], v[64:67], a[16:19], v[244:247]
    v_mul_f32 v138, v31, v138
    v_mul_f32 v139, v31, v139
    v_sub_f32 v248, v248, v136
    v_mfma_f32_16x16x32_bf16 v[48:51], v[68:71], a[16:19], v[48:51]
    s_waitcnt vmcnt(7)
    s_barrier
    buffer_store_dword v23, v225, s[8:11], 0 offen sc1
    v_mfma_f32_16x16x32_bf16 v[228:231], v[72:75], a[20:23], v[228:231]
    buffer_load_dwordx4 v6, s[12:15], s47 offen offset:1024 lds
    v_sub_f32 v249, v249, v137
    v_mfma_f32_16x16x32_bf16 v[32:35], v[76:79], a[20:23], v[32:35]
    v_sub_f32 v250, v250, v138
    v_sub_f32 v251, v251, v139
    v_fma_f32 v140, v136, v136, -v24
    v_mfma_f32_16x16x32_bf16 v[232:235], v[72:75], a[24:27], v[232:235]
    v_fma_f32 v141, v137, v137, -v24
    v_fma_f32 v142, v138, v138, -v24
    v_fma_f32 v143, v139, v139, -v24
    v_mfma_f32_16x16x32_bf16 v[36:39], v[76:79], a[24:27], v[36:39]
    s_add_u32 m0, s35, 4096
    s_add_u32 s47, s47, 98304
    v_fma_f32 v56, v56, v31, -v140
    v_mfma_f32_16x16x32_bf16 v[236:239], v[72:75], a[28:31], v[236:239]
    s_cmp_eq_u32 s47, s62
    s_cselect_b32 s47, s39, s47
    buffer_load_dwordx4 v5, s[12:15], s47 offen offset:0 lds
    v_mfma_f32_16x16x32_bf16 v[40:43], v[76:79], a[28:31], v[40:43]
    v_fma_f32 v57, v57, v31, -v141
    v_fma_f32 v58, v58, v31, -v142
    v_fma_f32 v59, v59, v31, -v143
    v_mfma_f32_16x16x32_bf16 v[240:243], v[72:75], a[32:35], v[240:243]
    v_max_f32 v56, v24, v56
    v_max_f32 v57, v24, v57
    v_max_f32 v58, v24, v58
    v_mfma_f32_16x16x32_bf16 v[44:47], v[76:79], a[32:35], v[44:47]
    buffer_load_dwordx4 v6, s[12:15], s47 offen offset:1024 lds
    v_max_f32 v59, v24, v59
    v_mfma_f32_16x16x32_bf16 v[244:247], v[72:75], a[36:39], v[244:247]
    v_rsq_f32 v56, v56
    v_rsq_f32 v57, v57
    v_rsq_f32 v58, v58
    v_rsq_f32 v59, v59
    v_mfma_f32_16x16x32_bf16 v[48:51], v[76:79], a[36:39], v[48:51]
    v_pk_mul_f32 v[248:249], v[248:249], v[56:57]
    v_pk_mul_f32 v[250:251], v[250:251], v[58:59]
    v_pk_mul_f32 v[252:253], v[56:57], v[214:215]
    v_pk_mul_f32 v[254:255], v[58:59], v[214:215]
    v_pk_mul_f32 v[64:65], v[56:57], v[26:27] op_sel:[0,0] op_sel_hi:[1,0]
    v_pk_mul_f32 v[66:67], v[58:59], v[26:27] op_sel:[0,0] op_sel_hi:[1,0]
    v_pk_mul_f32 v[68:69], v[252:253], v[26:27] op_sel:[0,0] op_sel_hi:[1,0]
    v_pk_mul_f32 v[70:71], v[254:255], v[26:27] op_sel:[0,0] op_sel_hi:[1,0]
    v_pk_mul_f32 v[72:73], v[56:57], v[26:27] op_sel:[0,1] op_sel_hi:[1,1]
    v_pk_mul_f32 v[74:75], v[58:59], v[26:27] op_sel:[0,1] op_sel_hi:[1,1]
    v_pk_mul_f32 v[76:77], v[252:253], v[26:27] op_sel:[0,1] op_sel_hi:[1,1]
    v_pk_mul_f32 v[78:79], v[254:255], v[26:27] op_sel:[0,1] op_sel_hi:[1,1]
    v_pk_mul_f32 v[80:81], v[248:249], v[28:29] op_sel:[0,1] op_sel_hi:[1,1]
    v_pk_mul_f32 v[82:83], v[250:251], v[28:29] op_sel:[0,1] op_sel_hi:[1,1]
    v_pk_fma_f32 v[96:97], v[96:97], v[56:57], v[248:249] neg_lo:[0,0,1] neg_hi:[0,0,1]
    v_pk_fma_f32 v[98:99], v[98:99], v[58:59], v[250:251] neg_lo:[0,0,1] neg_hi:[0,0,1]
    v_pk_fma_f32 v[96:97], v[116:117], v[252:253], v[96:97]
    v_pk_fma_f32 v[98:99], v[118:119], v[254:255], v[98:99]
    v_pk_fma_f32 v[96:97], v[228:229], v[64:65], v[96:97]
    v_pk_fma_f32 v[98:99], v[230:231], v[66:67], v[98:99]
    v_pk_fma_f32 v[96:97], v[32:33], v[68:69], v[96:97]
    v_pk_fma_f32 v[98:99], v[34:35], v[70:71], v[98:99]
    v_cvt_pk_bf16_f32 v84, v96, v97
    v_cvt_pk_bf16_f32 v85, v98, v99
    ds_write_b64 v208, v[84:85] offset:0
    v_pk_fma_f32 v[100:101], v[100:101], v[56:57], v[248:249] neg_lo:[0,0,1] neg_hi:[0,0,1]
    v_pk_fma_f32 v[102:103], v[102:103], v[58:59], v[250:251] neg_lo:[0,0,1] neg_hi:[0,0,1]
    v_pk_fma_f32 v[100:101], v[120:121], v[252:253], v[100:101]
    v_pk_fma_f32 v[102:103], v[122:123], v[254:255], v[102:103]
    v_pk_fma_f32 v[100:101], v[232:233], v[64:65], v[100:101]
    v_pk_fma_f32 v[102:103], v[234:235], v[66:67], v[102:103]
    v_pk_fma_f32 v[100:101], v[36:37], v[68:69], v[100:101]
    v_pk_fma_f32 v[102:103], v[38:39], v[70:71], v[102:103]
    v_cvt_pk_bf16_f32 v86, v100, v101
    v_cvt_pk_bf16_f32 v87, v102, v103
    ds_write_b64 v208, v[86:87] offset:1152
    v_pk_fma_f32 v[104:105], v[104:105], v[56:57], v[80:81] neg_lo:[0,0,1] neg_hi:[0,0,1]
    v_pk_fma_f32 v[106:107], v[106:107], v[58:59], v[82:83] neg_lo:[0,0,1] neg_hi:[0,0,1]
    v_pk_fma_f32 v[104:105], v[124:125], v[252:253], v[104:105]
    v_pk_fma_f32 v[106:107], v[126:127], v[254:255], v[106:107]
    v_pk_fma_f32 v[104:105], v[236:237], v[72:73], v[104:105]
    v_pk_fma_f32 v[106:107], v[238:239], v[74:75], v[106:107]
    v_pk_fma_f32 v[104:105], v[40:41], v[76:77], v[104:105]
    v_pk_fma_f32 v[106:107], v[42:43], v[78:79], v[106:107]
    v_cvt_pk_bf16_f32 v88, v104, v105
    v_cvt_pk_bf16_f32 v89, v106, v107
    ds_write_b64 v209, v[88:89] offset:2304
    v_pk_mul_f32 v[108:109], v[108:109], v[56:57]
    v_pk_mul_f32 v[110:111], v[110:111], v[58:59]
    v_pk_fma_f32 v[108:109], v[128:129], v[252:253], v[108:109]
    v_pk_fma_f32 v[110:111], v[130:131], v[254:255], v[110:111]
    v_pk_fma_f32 v[108:109], v[240:241], v[68:69], v[108:109]
    v_pk_fma_f32 v[110:111], v[242:243], v[70:71], v[110:111]
    v_pk_fma_f32 v[108:109], v[44:45], v[64:65], v[108:109]
    v_pk_fma_f32 v[110:111], v[46:47], v[66:67], v[110:111]
    v_cvt_pk_bf16_f32 v90, v108, v109
    v_cvt_pk_bf16_f32 v91, v110, v111
    ds_write_b64 v208, v[90:91] offset:704
    v_pk_mul_f32 v[112:113], v[112:113], v[56:57]
    v_pk_mul_f32 v[114:115], v[114:115], v[58:59]
    v_pk_fma_f32 v[112:113], v[132:133], v[252:253], v[112:113]
    v_pk_fma_f32 v[114:115], v[134:135], v[254:255], v[114:115]
    v_pk_fma_f32 v[112:113], v[244:245], v[68:69], v[112:113]
    v_pk_fma_f32 v[114:115], v[246:247], v[70:71], v[114:115]
    v_pk_fma_f32 v[112:113], v[48:49], v[64:65], v[112:113]
    v_pk_fma_f32 v[114:115], v[50:51], v[66:67], v[114:115]
    v_cvt_pk_bf16_f32 v92, v112, v113
    v_cvt_pk_bf16_f32 v93, v114, v115
    ds_write_b64 v208, v[92:93] offset:1856
    v_mul_f32 v248, v248, v216
    v_mul_f32 v249, v249, v216
    v_mul_f32 v250, v250, v216
    v_mul_f32 v251, v251, v216
    v_cvt_pk_bf16_f32 v94, v248, v249
    v_cvt_pk_bf16_f32 v95, v250, v251
    ds_write_b64 v213, v[94:95] offset:2880
    s_waitcnt lgkmcnt(0)
    s_barrier
    ds_read_b128 v[32:35], v217 offset:0
    ds_read_b128 v[36:39], v217 offset:64
    ds_read_b128 v[40:43], v217 offset:128
    ds_read_b128 v[44:47], v217 offset:192
    ds_read_b128 v[48:51], v217 offset:3168
    ds_read_b128 v[52:55], v217 offset:3232
    ds_read_b128 v[56:59], v217 offset:3296
    ds_read_b128 v[60:63], v217 offset:3360
    ds_read_b128 v[64:67], v217 offset:6336
    ds_read_b128 v[68:71], v217 offset:6400
    ds_read_b128 v[72:75], v217 offset:6464
    ds_read_b128 v[76:79], v217 offset:6528
    ds_read_b128 v[80:83], v217 offset:9504
    ds_read_b128 v[84:87], v217 offset:9568
    ds_read_b128 v[88:91], v217 offset:9632
    ds_read_b128 v[92:95], v217 offset:9696
    buffer_store_dwordx4 v[136:139], v221, s[8:11], s60 offen sc1
    s_waitcnt lgkmcnt(12)
    v_mfma_f32_16x16x32_bf16 v[96:99], v[148:151], v[32:35], 0
    v_mfma_f32_16x16x32_bf16 v[96:99], v[152:155], v[36:39], v[96:99]
    v_mfma_f32_16x16x32_bf16 v[96:99], v[156:159], v[40:43], v[96:99]
    v_mfma_f32_16x16x32_bf16 v[96:99], v[160:163], v[44:47], v[96:99]
    s_waitcnt lgkmcnt(8)
    v_mfma_f32_16x16x32_bf16 v[100:103], v[148:151], v[48:51], 0
    v_mfma_f32_16x16x32_bf16 v[100:103], v[152:155], v[52:55], v[100:103]
    v_mfma_f32_16x16x32_bf16 v[100:103], v[156:159], v[56:59], v[100:103]
    v_mfma_f32_16x16x32_bf16 v[100:103], v[160:163], v[60:63], v[100:103]
    s_waitcnt lgkmcnt(4)
    v_mfma_f32_16x16x32_bf16 v[104:107], v[148:151], v[64:67], 0
    v_mfma_f32_16x16x32_bf16 v[104:107], v[152:155], v[68:71], v[104:107]
    v_mfma_f32_16x16x32_bf16 v[104:107], v[156:159], v[72:75], v[104:107]
    v_mfma_f32_16x16x32_bf16 v[104:107], v[160:163], v[76:79], v[104:107]
    s_waitcnt lgkmcnt(0)
    v_mfma_f32_16x16x32_bf16 v[108:111], v[148:151], v[80:83], 0
    v_mfma_f32_16x16x32_bf16 v[108:111], v[152:155], v[84:87], v[108:111]
    v_mfma_f32_16x16x32_bf16 v[108:111], v[156:159], v[88:91], v[108:111]
    v_mfma_f32_16x16x32_bf16 v[108:111], v[160:163], v[92:95], v[108:111]
    v_cvt_pk_bf16_f32 v112, v96, v97
    v_cvt_pk_bf16_f32 v116, v98, v99
    v_cvt_pk_bf16_f32 v113, v100, v101
    v_cvt_pk_bf16_f32 v117, v102, v103
    v_cvt_pk_bf16_f32 v114, v104, v105
    v_cvt_pk_bf16_f32 v118, v106, v107
    s_nop 1
    v_cvt_pk_bf16_f32 v115, v108, v109
    v_cvt_pk_bf16_f32 v119, v110, v111
    buffer_store_dwordx4 v[112:115], v220, s[8:11], s58 offen sc1
    buffer_store_dwordx4 v[116:119], v220, s[8:11], s59 offen sc1
    s_waitcnt vmcnt(10)
    s_barrier
    ds_read_b64_tr_b16 v[128:129], v7 offset:0
    ds_read_b64_tr_b16 v[130:131], v7 offset:512
    ds_read_b64_tr_b16 v[132:133], v10 offset:0
    ds_read_b64_tr_b16 v[134:135], v10 offset:512
    ds_read_b64_tr_b16 v[120:121], v25 offset:0
    ds_read_b64_tr_b16 v[122:123], v25 offset:512
    ds_read_b64_tr_b16 v[124:125], v25 offset:1024
    ds_read_b64_tr_b16 v[126:127], v25 offset:1536
    s_lshl3_add_u32 s51, s28, s30
    s_cmp_ge_u32 s51, 20
    s_cselect_b32 s53, 1, 0
    s_mul_i32 s44, s29, 1280
    s_lshl_b32 s3, s51, 6
    s_add_u32 s44, s44, s3
    s_mov_b32 s50, s29
    s_sub_u32 s52, 32, s50
    s_and_b32 s52, s52, 31
    v_lshrrev_b32 v229, 2, v1
    v_mul_u32_u24 v229, 40960, v229
    v_and_b32 v230, 3, v1
    v_xor_b32 v230, v230, v3
    v_lshl_add_u32 v229, v230, 4, v229
    v_and_b32 v230, 31, v0
    v_bfe_u32 v231, v0, 5, 1
    s_waitcnt lgkmcnt(0)
    s_barrier
    buffer_store_dwordx4 v[128:131], v212, s[8:11], s45 offen sc1
    s_add_u32 s45, s45, 81920
    buffer_store_dwordx4 v[132:135], v212, s[8:11], s45 offen sc1
    buffer_store_dwordx4 v[120:123], v226, s[8:11], s0 offen sc1
    buffer_store_dwordx4 v[124:127], v226, s[8:11], s1 offen sc1
    s_cmp_lg_u32 s53, 0
    s_cbranch_scc1 L_nob1
    s_add_u32 m0, s36, 16384
    s_nop 0
    buffer_load_dwordx4 v229, s[4:7], s44 offen offset:0 lds
    s_add_u32 s44, s44, 654336
    buffer_load_dwordx4 v229, s[4:7], s44 offen offset:1024 lds
    s_add_u32 s44, s44, 654336
    buffer_load_dwordx4 v229, s[4:7], s44 offen offset:2048 lds
    s_add_u32 s44, s44, 654336
    buffer_load_dwordx4 v229, s[4:7], s44 offen offset:3072 lds
L_nob1:
    v_bfe_u32 v210, v230, 2, 2
    v_lshlrev_b32 v211, 1, v231
    v_xor_b32 v210, v210, v211
    v_lshlrev_b32 v210, 4, v210
    v_lshl_add_u32 v210, v230, 6, v210
    v_add_u32 v210, s36, v210
    v_xor_b32 v211, 16, v210
    s_lshl_b32 s54, s50, 8
    s_lshl_b32 s3, s52, 8
    s_add_u32 s3, s3, 128
    v_and_b32 v24, 1, v230
    v_cmp_eq_u32 vcc, 1, v24
    v_mov_b32 v26, s54
    v_mov_b32 v24, s3
    v_cndmask_b32 v26, v26, v24, vcc
    s_add_u32 m0, s36, 0
    s_add_u32 s47, s47, 98304
    s_cmp_eq_u32 s47, s62
    s_cselect_b32 s47, s39, s47
    buffer_load_dwordx4 v5, s[12:15], s47 offen offset:0 lds
    v_lshrrev_b32 v24, 1, v230
    v_lshl_add_u32 v26, v24, 2, v26
    v_bfe_u32 v24, v230, 2, 1
    v_lshlrev_b32 v27, 4, v24
    v_lshrrev_b32 v24, 3, v230
    v_lshl_add_u32 v27, v24, 2, v27
    v_and_b32 v24, 3, v230
    s_lshl_b32 s3, s51, 5
    v_add3_u32 v27, v27, v24, s3
    v_sub_u32 v24, 640, v27
    v_cmp_eq_u32 vcc, 320, v27
    v_min_u32 v24, v24, v27
    v_mov_b32 v25, 320
    v_cndmask_b32 v24, v24, 0, vcc
    v_cmp_eq_u32 vcc, 0, v27
    v_mul_u32_u24 v25, 1639, v24
    buffer_load_dwordx4 v6, s[12:15], s47 offen offset:1024 lds
    v_lshrrev_b32 v25, 16, v25
    v_mad_u32_u24 v24, v25, 8, v24
    v_mov_b32 v25, 40
    v_mul_u32_u24 v27, 6656, v231
    v_cndmask_b32 v24, v24, v25, vcc
    v_lshl_add_u32 v27, v24, 2, v27
    s_cmp_ge_u32 s51, 10
    s_cselect_b32 s46, s52, s50
    s_mul_i32 s46, s46, 53248
    s_cmp_eq_u32 s50, 0
    s_cselect_b32 s3, 64, 63
    v_sub_u32 v24, s3, v230
    s_cmp_ge_u32 s51, 10
    s_cselect_b64 vcc, -1, 0
    v_cndmask_b32 v24, v230, v24, vcc
    v_cvt_f32_u32 v24, v24
    v_mul_f32 v12, 0x3c800000, v24
    v_lshlrev_b32 v13, 2, v231
    v_cvt_f32_u32 v13, v13
    v_mul_f32 v13, v13, v12
    v_mul_f32 v14, 0.5, v24
    v_cos_f32 v14, v14
    s_mov_b32 s3, 5029888
    v_lshlrev_b32 v225, 4, v0
    buffer_load_dword v224, v225, s[8:11], s3 offen sc1
    v_cmp_eq_u32 vcc, 0, v231
    v_mul_f32 v15, 0x40a00000, v12
    v_cos_f32 v24, v13
    v_sin_f32 v25, -v13
    v_add_f32 v13, v13, v12
    v_cndmask_b32 v25, v25, v14, vcc
    v_cvt_pk_bf16_f32 v48, v24, v25
    v_cos_f32 v24, v13
    v_sin_f32 v25, -v13
    v_add_f32 v13, v13, v12
    v_cvt_pk_bf16_f32 v49, v24, v25
    v_cos_f32 v24, v13
    v_sin_f32 v25, -v13
    v_add_f32 v13, v13, v12
    v_cvt_pk_bf16_f32 v50, v24, v25
    v_cos_f32 v24, v13
    s_add_u32 m0, s36, 2048
    s_add_u32 s47, s47, 98304
    s_cmp_eq_u32 s47, s62
    s_cselect_b32 s47, s39, s47
    buffer_load_dwordx4 v5, s[12:15], s47 offen offset:0 lds
    v_sin_f32 v25, -v13
    v_add_f32 v13, v13, v15
    v_cvt_pk_bf16_f32 v51, v24, v25
    v_cos_f32 v24, v13
    v_sin_f32 v25, -v13
    v_add_f32 v13, v13, v12
    v_cvt_pk_bf16_f32 v52, v24, v25
    v_cos_f32 v24, v13
    v_sin_f32 v25, -v13
    v_add_f32 v13, v13, v12
    v_cvt_pk_bf16_f32 v53, v24, v25
    v_cos_f32 v24, v13
    v_sin_f32 v25, -v13
    v_add_f32 v13, v13, v12
    v_cvt_pk_bf16_f32 v54, v24, v25
    buffer_load_dwordx4 v6, s[12:15], s47 offen offset:1024 lds
    v_cos_f32 v24, v13
    v_sin_f32 v25, -v13
    v_add_f32 v13, v13, v15
    v_cvt_pk_bf16_f32 v55, v24, v25
    v_cos_f32 v24, v13
    v_sin_f32 v25, -v13
    v_add_f32 v13, v13, v12
    v_cvt_pk_bf16_f32 v56, v24, v25
    v_cos_f32 v24, v13
    v_sin_f32 v25, -v13
    v_add_f32 v13, v13, v12
    v_cvt_pk_bf16_f32 v57, v24, v25
    v_cos_f32 v24, v13
    v_sin_f32 v25, -v13
    v_add_f32 v13, v13, v12
    s_add_u32 m0, s36, 4096
    s_add_u32 s47, s47, 98304
    s_cmp_eq_u32 s47, s62
    s_cselect_b32 s47, s39, s47
    buffer_load_dwordx4 v5, s[12:15], s47 offen offset:0 lds
    v_cvt_pk_bf16_f32 v58, v24, v25
    v_cos_f32 v24, v13
    v_sin_f32 v25, -v13
    v_add_f32 v13, v13, v15
    v_cvt_pk_bf16_f32 v59, v24, v25
    v_cos_f32 v24, v13
    v_sin_f32 v25, -v13
    v_add_f32 v13, v13, v12
    v_cvt_pk_bf16_f32 v60, v24, v25
    v_cos_f32 v24, v13
    v_sin_f32 v25, -v13
    v_add_f32 v13, v13, v12
    v_cvt_pk_bf16_f32 v61, v24, v25
    v_cos_f32 v24, v13
    v_sin_f32 v25, -v13
    v_add_f32 v13, v13, v12
    buffer_load_dwordx4 v6, s[12:15], s47 offen offset:1024 lds
    v_cvt_pk_bf16_f32 v62, v24, v25
    v_cos_f32 v24, v13
    v_sin_f32 v25, -v13
    v_add_f32 v13, v13, v15
    v_cvt_pk_bf16_f32 v63, v24, v25
    v_mov_b32 v64, v48
    v_xor_b32 v65, 0x80008000, v49
    v_mov_b32 v66, v50
    v_xor_b32 v67, 0x80008000, v51
    v_mov_b32 v68, v52
    v_xor_b32 v69, 0x80008000, v53
    v_mov_b32 v70, v54
    v_xor_b32 v71, 0x80008000, v55
    v_mov_b32 v72, v56
    v_xor_b32 v73, 0x80008000, v57
    s_add_u32 m0, s36, 6144
    s_add_u32 s47, s47, 98304
    s_cmp_eq_u32 s47, s62
    s_cselect_b32 s47, s39, s47
    buffer_load_dwordx4 v5, s[12:15], s47 offen offset:0 lds
    v_mov_b32 v74, v58
    v_xor_b32 v75, 0x80008000, v59
    v_mov_b32 v76, v60
    v_xor_b32 v77, 0x80008000, v61
    v_mov_b32 v78, v62
    v_xor_b32 v79, 0x80008000, v63
    v_lshrrev_b32 v24, 4, v230
    v_mul_u32_u24 v28, 655360, v24
    v_lshl_add_u32 v28, v231, 9, v28
    v_lshl_add_u32 v28, v2, 4, v28
    s_mov_b32 s58, s73
    s_add_u32 s59, s73, 1310720
    s_mov_b32 s60, s76
    s_add_u32 s61, s54, 5021696
    s_cmp_eq_u32 s51, 0
    s_cselect_b32 s3, 0, 1073741824
    v_lshl_add_u32 v29, v2, 4, s3
    v_lshl_add_u32 v29, v3, 2, v29
    v_lshlrev_b32 v30, 2, v1
    s_lshl2_add_u32 s3, s33, s28
    s_mul_i32 s24, s3, 20480
    s_add_u32 s24, s24, 13631488
    s_add_u32 s25, s24, 20480
    s_lshl_b32 s3, s63, 10
    s_add_u32 s26, s24, s3
    buffer_load_dwordx4 v6, s[12:15], s47 offen offset:1024 lds
    s_mul_i32 s3, s28, 5
    s_add_u32 s63, s63, s3
    s_mul_i32 s49, s32, 20480
    s_add_u32 s49, s49, 2400256
    s_add_u32 s3, s63, 0
    s_cmp_ge_u32 s3, 20
    s_cselect_b32 s29, 20, 0
    s_sub_u32 s3, s3, s29
    s_lshl_b32 s3, s3, 10
    s_add_u32 s29, s3, s49
    s_add_u32 s3, s63, 1
    s_cmp_ge_u32 s3, 20
    s_cselect_b32 s30, 21, 1
    s_sub_u32 s3, s3, s30
    s_lshl_b32 s3, s3, 10
    s_add_u32 s30, s3, s49
    s_add_u32 s3, s63, 2
    s_cmp_ge_u32 s3, 20
    s_cselect_b32 s31, 22, 2
    s_sub_u32 s3, s3, s31
    s_lshl_b32 s3, s3, 10
    s_add_u32 s31, s3, s49
    s_add_u32 s3, s63, 3
    s_cmp_ge_u32 s3, 20
    s_cselect_b32 s37, 23, 3
    s_sub_u32 s3, s3, s37
    s_lshl_b32 s3, s3, 10
    s_add_u32 s37, s3, s49
    s_add_u32 s3, s63, 4
    s_cmp_ge_u32 s3, 20
    s_cselect_b32 s48, 20, 0
    s_sub_u32 s3, s3, s48
    s_lshl_b32 s3, s3, 10
    s_add_u32 s48, s3, s49
    s_mul_i32 s45, s32, 48
    s_mul_i32 s3, s33, 3
    s_add_u32 s45, s45, s3
    s_lshl_b32 s45, s45, 10
    s_add_u32 s45, s45, 7340032
    s_mul_i32 s40, s32, 4096
    s_lshl_b32 s3, s28, 6
    s_add_u32 s40, s40, s3
    s_add_u32 s40, s40, 2236416
    s_add_u32 s41, s40, 2048
    s_waitcnt vmcnt(6)
    ds_read_b128 v[232:235], v210 offset:16384
    ds_read_b128 v[236:239], v211 offset:16384
    ds_read_b128 v[240:243], v210 offset:18432
    ds_read_b128 v[244:247], v211 offset:18432
    v_cmp_ne_u32 vcc, s34, v224
    s_cbranch_vccnz RT_f1
BK_f1:
    s_barrier
    s_lshl_b32 s3, s2, 4
    s_add_u32 s3, s3, s55
    s_add_u32 s3, s3, 5046272
    v_lshrrev_b32 v22, 4, v1
    v_lshl_add_u32 v22, v22, 2, s3
    buffer_store_dword v23, v22, s[8:11], 0 offen sc1
    s_cmp_lg_u32 s53, 0
    s_cbranch_scc1 L_nob2
    s_mov_b32 s3, 2228224
    buffer_load_dword v12, v26, s[8:11], s3 offen offset:0 sc1
    buffer_load_dword v13, v26, s[8:11], s3 offen offset:64 sc1
    s_add_u32 s3, s46, 0
    buffer_load_dword v32, v27, s[8:11], s3 offen offset:0 sc1
    buffer_load_dword v33, v27, s[8:11], s3 offen offset:1664 sc1
    s_add_u32 s3, s46, 3328
    buffer_load_dword v34, v27, s[8:11], s3 offen offset:0 sc1
    buffer_load_dword v35, v27, s[8:11], s3 offen offset:1664 sc1
    s_add_u32 s3, s46, 13312
    buffer_load_dword v36, v27, s[8:11], s3 offen offset:0 sc1
    buffer_load_dword v37, v27, s[8:11], s3 offen offset:1664 sc1
    s_add_u32 s3, s46, 16640
    buffer_load_dword v38, v27, s[8:11], s3 offen offset:0 sc1
    buffer_load_dword v39, v27, s[8:11], s3 offen offset:1664 sc1
    s_add_u32 s3, s46, 26624
    buffer_load_dword v40, v27, s[8:11], s3 offen offset:0 sc1
    buffer_load_dword v41, v27, s[8:11], s3 offen offset:1664 sc1
    s_add_u32 s3, s46, 29952
    buffer_load_dword v42, v27, s[8:11], s3 offen offset:0 sc1
    buffer_load_dword v43, v27, s[8:11], s3 offen offset:1664 sc1
    s_add_u32 s3, s46, 39936
    buffer_load_dword v44, v27, s[8:11], s3 offen offset:0 sc1
    buffer_load_dword v45, v27, s[8:11], s3 offen offset:1664 sc1
    s_add_u32 s3, s46, 43264
    buffer_load_dword v46, v27, s[8:11], s3 offen offset:0 sc1
    buffer_load_dword v47, v27, s[8:11], s3 offen offset:1664 sc1
L_nob2:
    s_waitcnt lgkmcnt(0)
    v_lshlrev_b32 v80, 16, v232
    v_and_b32 v81, 0xffff0000, v232
    s_add_u32 m0, s36, 8192
    s_add_u32 s47, s47, 98304
    s_cmp_eq_u32 s47, s62
    s_cselect_b32 s47, s39, s47
    buffer_load_dwordx4 v5, s[12:15], s47 offen offset:0 lds
    v_lshlrev_b32 v82, 16, v233
    v_and_b32 v83, 0xffff0000, v233
    v_lshlrev_b32 v84, 16, v234
    buffer_load_dwordx4 v6, s[12:15], s47 offen offset:1024 lds
    v_and_b32 v85, 0xffff0000, v234
    v_lshlrev_b32 v86, 16, v235
    v_and_b32 v87, 0xffff0000, v235
    v_lshlrev_b32 v88, 16, v236
    s_add_u32 m0, s36, 10240
    s_add_u32 s47, s47, 98304
    s_cmp_eq_u32 s47, s62
    s_cselect_b32 s47, s39, s47
    buffer_load_dwordx4 v5, s[12:15], s47 offen offset:0 lds
    v_and_b32 v89, 0xffff0000, v236
    v_lshlrev_b32 v90, 16, v237
    v_and_b32 v91, 0xffff0000, v237
    v_lshlrev_b32 v92, 16, v238
    buffer_load_dwordx4 v6, s[12:15], s47 offen offset:1024 lds
    v_and_b32 v93, 0xffff0000, v238
    v_lshlrev_b32 v94, 16, v239
    v_and_b32 v95, 0xffff0000, v239
    s_add_u32 m0, s36, 12288
    s_add_u32 s47, s47, 98304
    s_cmp_eq_u32 s47, s62
    s_cselect_b32 s47, s39, s47
    buffer_load_dwordx4 v5, s[12:15], s47 offen offset:0 lds
    v_mov_b32 v14, v80
    v_lshlrev_b32 v96, 16, v240
    v_and_b32 v97, 0xffff0000, v240
    v_lshlrev_b32 v98, 16, v241
    buffer_load_dwordx4 v6, s[12:15], s47 offen offset:1024 lds
    v_and_b32 v99, 0xffff0000, v241
    v_lshlrev_b32 v100, 16, v242
    v_and_b32 v101, 0xffff0000, v242
    v_lshlrev_b32 v102, 16, v243
    s_add_u32 m0, s36, 14336
    s_add_u32 s47, s47, 98304
    s_cmp_eq_u32 s47, s62
    s_cselect_b32 s47, s39, s47
    buffer_load_dwordx4 v5, s[12:15], s47 offen offset:0 lds
    v_and_b32 v103, 0xffff0000, v243
    v_lshlrev_b32 v104, 16, v244
    v_and_b32 v105, 0xffff0000, v244
    buffer_load_dwordx4 v6, s[12:15], s47 offen offset:1024 lds
    v_lshlrev_b32 v106, 16, v245
    v_and_b32 v107, 0xffff0000, v245
    v_lshlrev_b32 v108, 16, v246
    v_and_b32 v109, 0xffff0000, v246
    s_add_u32 m0, s36, 16384
    s_add_u32 s47, s47, 98304
    s_cmp_eq_u32 s47, s62
    s_cselect_b32 s47, s39, s47
    buffer_load_dwordx4 v5, s[12:15], s47 offen offset:0 lds
    v_lshlrev_b32 v110, 16, v247
    v_and_b32 v111, 0xffff0000, v247
    v_mov_b32 v15, v96
    ds_read_b64_tr_b16 a[0:1], v8 offset:0
    buffer_load_dwordx4 v6, s[12:15], s47 offen offset:1024 lds
    ds_read_b64_tr_b16 a[2:3], v8 offset:512
    ds_read_b64_tr_b16 a[4:5], v8 offset:40960
    ds_read_b64_tr_b16 a[6:7], v8 offset:41472
    s_add_u32 m0, s36, 18432
    s_add_u32 s47, s47, 98304
    s_cmp_eq_u32 s47, s62
    s_cselect_b32 s47, s39, s47
    buffer_load_dwordx4 v5, s[12:15], s47 offen offset:0 lds
    ds_read_b64_tr_b16 a[12:13], v8 offset:2048
    ds_read_b64_tr_b16 a[14:15], v8 offset:2560
    ds_read_b64_tr_b16 a[16:17], v8 offset:43008
    ds_read_b64_tr_b16 a[18:19], v8 offset:43520
    buffer_load_dwordx4 v6, s[12:15], s47 offen offset:1024 lds
    ds_read_b64_tr_b16 a[24:25], v8 offset:4096
    ds_read_b64_tr_b16 a[26:27], v8 offset:4608
    ds_read_b64_tr_b16 a[28:29], v8 offset:45056
    ds_read_b64_tr_b16 a[30:31], v8 offset:45568
    s_add_u32 m0, s35, 6144
    s_add_u32 s47, s47, 98304
    s_cmp_eq_u32 s47, s62
    s_cselect_b32 s47, s39, s47
    buffer_load_dwordx4 v5, s[12:15], s47 offen offset:0 lds
    ds_read_b64_tr_b16 a[36:37], v9 offset:0
    ds_read_b64_tr_b16 a[38:39], v9 offset:512
    ds_read_b64_tr_b16 a[40:41], v9 offset:40960
    buffer_load_dwordx4 v6, s[12:15], s47 offen offset:1024 lds
    ds_read_b64_tr_b16 a[42:43], v9 offset:41472
    s_and_b32 s3, s33, 7
    s_mul_i32 s3, s3, 5120
    s_mul_i32 s0, s28, 491520
    s_add_u32 s0, s0, s3
    s_add_u32 s0, s0, 5242880
    s_cmp_lg_u32 s53, 0
    s_cbranch_scc1 L_nob3
    s_waitcnt vmcnt(30)
    v_max_u32 v24, v12, v13
    v_cmp_eq_u32 vcc, -1, v24
    s_cbranch_vccnz RT_bm
BK_bm:
    v_pk_add_f32 v[80:81], v[80:81], v[12:13] op_sel:[0,0] op_sel_hi:[1,0] neg_lo:[0,1] neg_hi:[0,1]
    v_pk_add_f32 v[82:83], v[82:83], v[12:13] op_sel:[0,0] op_sel_hi:[1,0] neg_lo:[0,1] neg_hi:[0,1]
    v_pk_add_f32 v[84:85], v[84:85], v[12:13] op_sel:[0,0] op_sel_hi:[1,0] neg_lo:[0,1] neg_hi:[0,1]
    v_pk_add_f32 v[86:87], v[86:87], v[12:13] op_sel:[0,0] op_sel_hi:[1,0] neg_lo:[0,1] neg_hi:[0,1]
    v_pk_add_f32 v[88:89], v[88:89], v[12:13] op_sel:[0,0] op_sel_hi:[1,0] neg_lo:[0,1] neg_hi:[0,1]
    v_pk_add_f32 v[90:91], v[90:91], v[12:13] op_sel:[0,0] op_sel_hi:[1,0] neg_lo:[0,1] neg_hi:[0,1]
    v_pk_add_f32 v[92:93], v[92:93], v[12:13] op_sel:[0,0] op_sel_hi:[1,0] neg_lo:[0,1] neg_hi:[0,1]
    v_pk_add_f32 v[94:95], v[94:95], v[12:13] op_sel:[0,0] op_sel_hi:[1,0] neg_lo:[0,1] neg_hi:[0,1]
    v_pk_add_f32 v[96:97], v[96:97], v[12:13] op_sel:[0,1] op_sel_hi:[1,1] neg_lo:[0,1] neg_hi:[0,1]
    v_pk_add_f32 v[98:99], v[98:99], v[12:13] op_sel:[0,1] op_sel_hi:[1,1] neg_lo:[0,1] neg_hi:[0,1]
    v_pk_add_f32 v[100:101], v[100:101], v[12:13] op_sel:[0,1] op_sel_hi:[1,1] neg_lo:[0,1] neg_hi:[0,1]
    v_pk_add_f32 v[102:103], v[102:103], v[12:13] op_sel:[0,1] op_sel_hi:[1,1] neg_lo:[0,1] neg_hi:[0,1]
    v_pk_add_f32 v[104:105], v[104:105], v[12:13] op_sel:[0,1] op_sel_hi:[1,1] neg_lo:[0,1] neg_hi:[0,1]
    v_pk_add_f32 v[106:107], v[106:107], v[12:13] op_sel:[0,1] op_sel_hi:[1,1] neg_lo:[0,1] neg_hi:[0,1]
    v_pk_add_f32 v[108:109], v[108:109], v[12:13] op_sel:[0,1] op_sel_hi:[1,1] neg_lo:[0,1] neg_hi:[0,1]
    v_pk_add_f32 v[110:111], v[110:111], v[12:13] op_sel:[0,1] op_sel_hi:[1,1] neg_lo:[0,1] neg_hi:[0,1]
    s_waitcnt vmcnt(14)
    v_max3_u32 v24, v32, v33, v34
    v_max3_u32 v24, v24, v35, v36
    v_max3_u32 v24, v24, v37, v38
    v_max3_u32 v24, v24, v39, v40
    v_max3_u32 v24, v24, v41, v42
    v_max3_u32 v24, v24, v43, v44
    v_max3_u32 v24, v24, v45, v46
    v_max_u32 v24, v24, v47
    v_cmp_eq_u32 vcc, -1, v24
    s_cbranch_vccnz RT_bv
BK_bv:
    v_mfma_f32_32x32x16_bf16 v[80:95], v[32:35], v[48:51], v[80:95]
    s_add_u32 m0, s35, 8192
    s_add_u32 s47, s47, 98304
    s_cmp_eq_u32 s47, s62
    s_cselect_b32 s47, s39, s47
    buffer_load_dwordx4 v5, s[12:15], s47 offen offset:0 lds
    v_mfma_f32_32x32x16_bf16 v[80:95], v[36:39], v[52:55], v[80:95]
    v_mfma_f32_32x32x16_bf16 v[80:95], v[40:43], v[56:59], v[80:95]
    buffer_load_dwordx4 v6, s[12:15], s47 offen offset:1024 lds
    v_mfma_f32_32x32x16_bf16 v[80:95], v[44:47], v[60:63], v[80:95]
    v_mfma_f32_32x32x16_bf16 v[96:111], v[32:35], v[64:67], v[96:111]
    s_add_u32 m0, s35, 10240
    s_add_u32 s47, s47, 98304
    s_cmp_eq_u32 s47, s62
    s_cselect_b32 s47, s39, s47
    buffer_load_dwordx4 v5, s[12:15], s47 offen offset:0 lds
    v_mfma_f32_32x32x16_bf16 v[96:111], v[36:39], v[68:71], v[96:111]
    v_mfma_f32_32x32x16_bf16 v[96:111], v[40:43], v[72:75], v[96:111]
    buffer_load_dwordx4 v6, s[12:15], s47 offen offset:1024 lds
    v_mfma_f32_32x32x16_bf16 v[96:111], v[44:47], v[76:79], v[96:111]
    s_nop 1
    v_cvt_pk_bf16_f32 v232, v80, v81
    v_cvt_pk_bf16_f32 v233, v82, v83
    v_cvt_pk_bf16_f32 v234, v84, v85
    v_cvt_pk_bf16_f32 v235, v86, v87
    buffer_store_dwordx4 v[232:235], v28, s[8:11], s58 offen offset:0 sc1
    v_cvt_pk_bf16_f32 v236, v88, v89
    v_cvt_pk_bf16_f32 v237, v90, v91
    v_cvt_pk_bf16_f32 v238, v92, v93
    v_cvt_pk_bf16_f32 v239, v94, v95
    buffer_store_dwordx4 v[236:239], v28, s[8:11], s58 offen offset:256 sc1
    v_cvt_pk_bf16_f32 v240, v96, v97
    v_cvt_pk_bf16_f32 v241, v98, v99
    v_cvt_pk_bf16_f32 v242, v100, v101
    v_cvt_pk_bf16_f32 v243, v102, v103
    buffer_store_dwordx4 v[240:243], v28, s[8:11], s59 offen offset:0 sc1
    v_cvt_pk_bf16_f32 v244, v104, v105
    v_cvt_pk_bf16_f32 v245, v106, v107
    v_cvt_pk_bf16_f32 v246, v108, v109
    v_cvt_pk_bf16_f32 v247, v110, v111
    buffer_store_dwordx4 v[244:247], v28, s[8:11], s59 offen offset:256 sc1
    v_sub_f32 v14, v14, v80
    v_sub_f32 v15, v15, v96
    s_nop 1
    v_permlane32_swap_b32 v14, v15
    buffer_store_dword v14, v29, s[8:11], s61 offen sc1
    s_waitcnt vmcnt(9)
    s_branch L_bdone
L_nob3:
    s_add_u32 m0, s35, 8192
    s_add_u32 s47, s47, 98304
    s_cmp_eq_u32 s47, s62
    s_cselect_b32 s47, s39, s47
    buffer_load_dwordx4 v5, s[12:15], s47 offen offset:0 lds
    buffer_load_dwordx4 v6, s[12:15], s47 offen offset:1024 lds
    s_add_u32 m0, s35, 10240
    s_add_u32 s47, s47, 98304
    s_cmp_eq_u32 s47, s62
    s_cselect_b32 s47, s39, s47
    buffer_load_dwordx4 v5, s[12:15], s47 offen offset:0 lds
    buffer_load_dwordx4 v6, s[12:15], s47 offen offset:1024 lds
    s_waitcnt vmcnt(4)
L_bdone:
    s_waitcnt lgkmcnt(0)
    s_barrier
    ds_read_b64_tr_b16 a[48:49], v9 offset:2048
    v_mul_f32 v26, v80, v80
    ds_read_b64_tr_b16 a[50:51], v9 offset:2560
    v_mul_f32 v27, v96, v96
    s_add_u32 m0, s35, 12288
    s_add_u32 s47, s47, 98304
    s_cmp_eq_u32 s47, s62
    s_cselect_b32 s47, s39, s47
    buffer_load_dwordx4 v5, s[12:15], s47 offen offset:0 lds
    ds_read_b64_tr_b16 a[52:53], v9 offset:43008
    v_fmac_f32 v26, v81, v81
    ds_read_b64_tr_b16 a[54:55], v9 offset:43520
    v_fmac_f32 v27, v97, v97
    ds_read_b64_tr_b16 a[60:61], v9 offset:4096
    v_fmac_f32 v26, v82, v82
    ds_read_b64_tr_b16 a[62:63], v9 offset:4608
    v_fmac_f32 v27, v98, v98
    ds_read_b64_tr_b16 a[64:65], v9 offset:45056
    buffer_load_dwordx4 v6, s[12:15], s47 offen offset:1024 lds
    v_fmac_f32 v26, v83, v83
    ds_read_b64_tr_b16 a[66:67], v9 offset:45568
    ds_read_b64_tr_b16 a[72:73], v9 offset:6144
    v_fmac_f32 v27, v99, v99
    ds_read_b64_tr_b16 a[74:75], v9 offset:6656
    v_fmac_f32 v26, v84, v84
    ds_read_b64_tr_b16 a[76:77], v9 offset:47104
    v_fmac_f32 v27, v100, v100
    s_mov_b32 s3, 5046272
    buffer_load_dword v209, v225, s[8:11], s3 offen sc1
    ds_read_b64_tr_b16 a[78:79], v9 offset:47616
    v_fmac_f32 v26, v85, v85
    ds_read_b64_tr_b16 a[84:85], v9 offset:8192
    v_fmac_f32 v27, v101, v101
    ds_read_b64_tr_b16 a[86:87], v9 offset:8704
    v_fmac_f32 v26, v86, v86
    ds_read_b64_tr_b16 a[88:89], v9 offset:49152
    v_fmac_f32 v27, v102, v102
    ds_read_b64_tr_b16 a[90:91], v9 offset:49664
    s_add_u32 m0, s35, 14336
    s_add_u32 s47, s47, 98304
    s_cmp_eq_u32 s47, s62
    s_cselect_b32 s47, s39, s47
    buffer_load_dwordx4 v5, s[12:15], s47 offen offset:0 lds
    ds_read_b64_tr_b16 a[96:97], v9 offset:10240
    v_fmac_f32 v26, v87, v87
    ds_read_b64_tr_b16 a[98:99], v9 offset:10752
    v_fmac_f32 v27, v103, v103
    ds_read_b64_tr_b16 a[100:101], v9 offset:51200
    v_fmac_f32 v26, v88, v88
    ds_read_b64_tr_b16 a[102:103], v9 offset:51712
    buffer_load_dwordx4 v6, s[12:15], s47 offen offset:1024 lds
    v_fmac_f32 v27, v104, v104
    ds_read_b64_tr_b16 a[108:109], v9 offset:12288
    v_fmac_f32 v26, v89, v89
    ds_read_b64_tr_b16 a[110:111], v9 offset:12800
    v_fmac_f32 v27, v105, v105
    ds_read_b64_tr_b16 a[112:113], v9 offset:53248
    v_fmac_f32 v26, v90, v90
    ds_read_b64_tr_b16 a[114:115], v9 offset:53760
    s_add_u32 m0, s35, 16384
    s_add_u32 s47, s47, 98304
    s_cmp_eq_u32 s47, s62
    s_cselect_b32 s47, s39, s47
    buffer_load_dwordx4 v5, s[12:15], s47 offen offset:0 lds
    ds_read_b64_tr_b16 a[120:121], v9 offset:14336
    v_fmac_f32 v27, v106, v106
    ds_read_b64_tr_b16 a[122:123], v9 offset:14848
    v_fmac_f32 v26, v91, v91
    ds_read_b64_tr_b16 a[124:125], v9 offset:55296
    v_fmac_f32 v27, v107, v107
    ds_read_b64_tr_b16 a[126:127], v9 offset:55808
    v_fmac_f32 v26, v92, v92
    ds_read_b64_tr_b16 a[132:133], v9 offset:16384
    buffer_load_dwordx4 v6, s[12:15], s47 offen offset:1024 lds
    v_fmac_f32 v27, v108, v108
    ds_read_b64_tr_b16 a[134:135], v9 offset:16896
    v_fmac_f32 v26, v93, v93
    ds_read_b64_tr_b16 a[136:137], v9 offset:57344
    v_fmac_f32 v27, v109, v109
    ds_read_b64_tr_b16 a[138:139], v9 offset:57856
    ds_read_b64_tr_b16 a[144:145], v9 offset:18432
    v_fmac_f32 v26, v94, v94
    s_add_u32 m0, s35, 18432
    s_add_u32 s47, s47, 98304
    s_cmp_eq_u32 s47, s62
    s_cselect_b32 s47, s39, s47
    buffer_load_dwordx4 v5, s[12:15], s47 offen offset:0 lds
    ds_read_b64_tr_b16 a[146:147], v9 offset:18944
    v_fmac_f32 v27, v110, v110
    ds_read_b64_tr_b16 a[148:149], v9 offset:59392
    v_fmac_f32 v26, v95, v95
    ds_read_b64_tr_b16 a[150:151], v9 offset:59904
    v_fmac_f32 v27, v111, v111
    ds_read_b64_tr_b16 a[156:157], v8 offset:6144
    s_nop 1
    v_permlane32_swap_b32 v26, v27
    v_add_f32 v26, v26, v27
    ds_read_b64_tr_b16 a[158:159], v8 offset:6656
    buffer_load_dwordx4 v6, s[12:15], s47 offen offset:1024 lds
    s_cmp_lg_u32 s53, 0
    s_cselect_b64 vcc, -1, 0
    v_lshlrev_b32 v27, 2, v0
    v_cndmask_b32 v26, v26, 0, vcc
    ds_read_b64_tr_b16 a[160:161], v8 offset:47104
    ds_write_b32 v27, v26
    ds_read_b64_tr_b16 a[162:163], v8 offset:47616
    s_waitcnt vmcnt(6)
    v_cmp_ne_u32 vcc, s34, v209
    s_cbranch_vccnz RT_rf
BK_rf:
    s_waitcnt lgkmcnt(0)
    s_barrier
    ds_read2st64_b32 v[26:27], v30 offset0:0 offset1:1
    ds_read_b32 v24, v30 offset:512
    buffer_load_dwordx4 a[8:11], v4, s[8:11], s26 offen sc1
    s_waitcnt lgkmcnt(0)
    v_add_f32 v26, v26, v27
    v_add_f32 v26, v26, v24
    buffer_store_dword v26, v21, s[8:11], s60 offen sc1
    v_add_u32 v11, 81920, v4
    s_add_u32 s26, s26, 1024
    s_cmp_eq_u32 s26, s25
    s_cselect_b32 s26, s24, s26
    buffer_load_dwordx4 a[20:23], v4, s[8:11], s26 offen sc1
    v_add_u32 v12, 122880, v4
    s_add_u32 s26, s26, 1024
    s_cmp_eq_u32 s26, s25
    s_cselect_b32 s26, s24, s26
    buffer_load_dwordx4 a[32:35], v4, s[8:11], s26 offen sc1
    v_add_u32 v15, s35, v4
    s_add_u32 s26, s26, 1024
    s_cmp_eq_u32 s26, s25
    s_cselect_b32 s26, s24, s26
    buffer_load_dwordx4 a[44:47], v4, s[8:11], s26 offen sc1
    v_lshlrev_b32 v14, 3, v2
    s_add_u32 s26, s26, 1024
    s_cmp_eq_u32 s26, s25
    s_cselect_b32 s26, s24, s26
    buffer_load_dwordx4 a[56:59], v4, s[8:11], s26 offen sc1
    v_add_u32 v14, 100352, v14
    s_add_u32 s26, s26, 1024
    s_cmp_eq_u32 s26, s25
    s_cselect_b32 s26, s24, s26
    buffer_load_dwordx4 a[68:71], v4, s[8:11], s26 offen sc1
    v_mul_u32_u24 v25, 512, v3
    s_add_u32 s26, s26, 1024
    s_cmp_eq_u32 s26, s25
    s_cselect_b32 s26, s24, s26
    buffer_load_dwordx4 a[80:83], v4, s[8:11], s26 offen sc1
    v_lshl_add_u32 v25, v2, 2, v25
    s_add_u32 s26, s26, 1024
    s_cmp_eq_u32 s26, s25
    s_cselect_b32 s26, s24, s26
    buffer_load_dwordx4 a[92:95], v4, s[8:11], s26 offen sc1
    s_lshl_b32 s3, s28, 8
    v_lshl_add_u32 v13, v2, 4, s3
    v_lshl_add_u32 v13, v3, 10, v13
    v_cmp_eq_u32 vcc, 3, v3
    v_mov_b32 v24, 1073741824
    v_add_u32 v5, s36, v4
    v_cndmask_b32 v13, v13, v24, vcc
    s_add_u32 m0, s36, 0
    v_add_u32 v0, 0, v4
    buffer_load_dwordx4 v0, s[8:11], s29 offen offset:0 sc1 lds
    buffer_load_dwordx4 v0, s[8:11], s30 offen offset:1024 sc1 lds
    buffer_load_dwordx4 v0, s[8:11], s31 offen offset:2048 sc1 lds
    buffer_load_dwordx4 v0, s[8:11], s37 offen offset:3072 sc1 lds
    s_add_u32 m0, s36, 4096
    s_nop 0
    buffer_load_dwordx4 v0, s[8:11], s48 offen offset:0 sc1 lds
    s_add_u32 s26, s26, 1024
    s_cmp_eq_u32 s26, s25
    s_cselect_b32 s26, s24, s26
    buffer_load_dwordx4 a[104:107], v4, s[8:11], s26 offen sc1
    ds_read_b64_tr_b16 a[168:169], v8 offset:8192
    s_add_u32 s26, s26, 1024
    s_cmp_eq_u32 s26, s25
    s_cselect_b32 s26, s24, s26
    buffer_load_dwordx4 a[116:119], v4, s[8:11], s26 offen sc1
    ds_read_b64_tr_b16 a[170:171], v8 offset:8704
    s_add_u32 s26, s26, 1024
    s_cmp_eq_u32 s26, s25
    s_cselect_b32 s26, s24, s26
    buffer_load_dwordx4 a[128:131], v4, s[8:11], s26 offen sc1
    ds_read_b64_tr_b16 a[172:173], v8 offset:49152
    s_add_u32 s26, s26, 1024
    s_cmp_eq_u32 s26, s25
    s_cselect_b32 s26, s24, s26
    buffer_load_dwordx4 a[140:143], v4, s[8:11], s26 offen sc1
    ds_read_b64_tr_b16 a[174:175], v8 offset:49664
    s_add_u32 s26, s26, 1024
    s_cmp_eq_u32 s26, s25
    s_cselect_b32 s26, s24, s26
    buffer_load_dwordx4 a[152:155], v4, s[8:11], s26 offen sc1
    ds_read_b64_tr_b16 a[180:181], v8 offset:10240
    s_add_u32 s26, s26, 1024
    s_cmp_eq_u32 s26, s25
    s_cselect_b32 s26, s24, s26
    buffer_load_dwordx4 a[164:167], v4, s[8:11], s26 offen sc1
    ds_read_b64_tr_b16 a[182:183], v8 offset:10752
    s_add_u32 s26, s26, 1024
    s_cmp_eq_u32 s26, s25
    s_cselect_b32 s26, s24, s26
    buffer_load_dwordx4 a[176:179], v4, s[8:11], s26 offen sc1
    ds_read_b64_tr_b16 a[184:185], v8 offset:51200
    s_add_u32 s26, s26, 1024
    s_cmp_eq_u32 s26, s25
    s_cselect_b32 s26, s24, s26
    buffer_load_dwordx4 a[188:191], v4, s[8:11], s26 offen sc1
    ds_read_b64_tr_b16 a[186:187], v8 offset:51712
    s_add_u32 m0, s36, 5120
    s_lshr_b32 s54, s33, 3
    s_and_b32 s55, s33, 7
    v_add_u32 v0, 327680, v4
    s_lshl_b32 s3, s54, 4
    s_add_u32 s56, s3, s32
    s_mul_i32 s52, s56, 48
    s_mul_i32 s3, s28, 12
    s_add_u32 s52, s52, s3
    s_lshl_b32 s52, s52, 10
    s_add_u32 s52, s52, 7340032
    buffer_load_dwordx4 v0, s[8:11], s29 offen offset:0 sc1 lds
    s_mul_i32 s57, s56, 20480
    s_mul_i32 s3, s55, 2560
    s_add_u32 s57, s57, s3
    s_lshl_b32 s3, s28, 6
    s_add_u32 s57, s57, s3
    s_add_u32 s57, s57, 2400256
    buffer_load_dwordx4 v0, s[8:11], s30 offen offset:1024 sc1 lds
    s_lshl_b32 s56, s32, 1
    s_add_u32 s56, s56, s54
    s_lshl_b32 s58, s56, 8
    s_lshl_b32 s3, s28, 6
    s_add_u32 s58, s58, s3
    s_add_u32 s58, s58, 5021696
    buffer_load_dwordx4 v0, s[8:11], s31 offen offset:2048 sc1 lds
    s_mul_i32 s59, s56, 1280
    s_mul_i32 s3, s55, 160
    s_add_u32 s59, s59, s3
    s_mul_i32 s3, s28, 163840
    s_add_u32 s59, s59, s3
    s_mul_i32 s61, s55, 6
    s_sub_u32 s61, 56, s61
    buffer_load_dwordx4 v0, s[8:11], s37 offen offset:3072 sc1 lds
    s_lshl_b32 s3, s32, 4
    s_add_u32 s56, s3, s33
    s_lshl_b32 s56, s56, 9
    s_add_u32 s42, s56, 5062656
    s_cmp_eq_u32 s28, 0
    s_cselect_b32 s42, s42, 1073741824
    s_add_u32 m0, s36, 9216
    s_nop 0
    buffer_load_dwordx4 v0, s[8:11], s48 offen offset:0 sc1 lds
    s_lshl_b32 s3, s32, 13
    s_lshl_b32 s56, s28, 11
    s_add_u32 s3, s3, s56
    s_add_u32 s43, s3, 5062656
    s_mul_i32 s46, s28, 1344
    s_add_u32 s46, s46, 81920
    s_waitcnt vmcnt(13)
    ds_read2st64_b32 v[72:73], v5 offset0:0 offset1:4
    ds_read2st64_b32 v[74:75], v5 offset0:8 offset1:12
    ds_read_b32 v76, v5 offset:4096
    s_waitcnt lgkmcnt(0)
    v_max3_u32 v77, v72, v73, v74
    v_max3_u32 v77, v77, v75, v76
    v_cmp_eq_u32 vcc, -1, v77
    s_cbranch_vccnz RT_h0
BK_h0:
    s_barrier
    ds_read_b128 v[28:31], v11 offset:0
    ds_read_b128 v[32:35], v11 offset:1024
    ds_read_b128 v[36:39], v11 offset:2048
    ds_read_b128 v[40:43], v11 offset:3072
    s_waitcnt lgkmcnt(2)
    v_mfma_f32_16x16x32_bf16 v[48:51], a[0:3], v[28:31], 0
    buffer_load_dword v96, v25, s[8:11], s40 offen offset:0 sc1
    v_mfma_f32_16x16x32_bf16 v[48:51], a[12:15], v[32:35], v[48:51]
    ds_read_b128 v[44:47], v11 offset:4096
    buffer_load_dword v97, v25, s[8:11], s40 offen offset:256 sc1
    v_mfma_f32_16x16x32_bf16 v[52:55], a[4:7], v[28:31], 0
    ds_read_b64_tr_b16 a[192:193], v8 offset:12288
    ds_read_b64_tr_b16 a[194:195], v8 offset:12800
    v_mfma_f32_16x16x32_bf16 v[52:55], a[16:19], v[32:35], v[52:55]
    buffer_load_dword v101, v25, s[8:11], s41 offen offset:0 sc1
    v_mfma_f32_16x16x32_bf16 v[56:59], a[8:11], v[28:31], 0
    ds_read_b128 v[28:31], v11 offset:20480
    ds_read_b64_tr_b16 a[196:197], v8 offset:53248
    v_mfma_f32_16x16x32_bf16 v[56:59], a[20:23], v[32:35], v[56:59]
    ds_read_b128 v[32:35], v11 offset:21504
    buffer_load_dword v102, v25, s[8:11], s41 offen offset:256 sc1
    s_waitcnt lgkmcnt(6)
    v_mfma_f32_16x16x32_bf16 v[48:51], a[24:27], v[36:39], v[48:51]
    s_add_u32 s26, s26, 1024
    s_cmp_eq_u32 s26, s25
    s_cselect_b32 s26, s24, s26
    v_mfma_f32_16x16x32_bf16 v[48:51], a[36:39], v[40:43], v[48:51]
    buffer_load_dwordx4 a[200:203], v4, s[8:11], s26 offen sc1
    ds_read_b64_tr_b16 a[198:199], v8 offset:53760
    v_mfma_f32_16x16x32_bf16 v[52:55], a[28:31], v[36:39], v[52:55]
    ds_read_b64_tr_b16 a[204:205], v8 offset:14336
    ds_read_b64_tr_b16 a[206:207], v8 offset:14848
    v_mfma_f32_16x16x32_bf16 v[52:55], a[40:43], v[40:43], v[52:55]
    s_add_u32 s26, s26, 1024
    s_cmp_eq_u32 s26, s25
    s_cselect_b32 s26, s24, s26
    v_mfma_f32_16x16x32_bf16 v[56:59], a[32:35], v[36:39], v[56:59]
    ds_read_b128 v[36:39], v11 offset:22528
    buffer_load_dwordx4 a[212:215], v4, s[8:11], s26 offen sc1
    v_mfma_f32_16x16x32_bf16 v[56:59], a[44:47], v[40:43], v[56:59]
    ds_read_b128 v[40:43], v11 offset:23552
    ds_read_b64_tr_b16 a[208:209], v8 offset:55296
    s_waitcnt lgkmcnt(8)
    v_mfma_f32_16x16x32_bf16 v[48:51], a[48:51], v[44:47], v[48:51]
    s_add_u32 s26, s26, 1024
    s_cmp_eq_u32 s26, s25
    s_cselect_b32 s26, s24, s26
    v_mfma_f32_16x16x32_bf16 v[48:51], a[60:63], v[28:31], v[48:51]
    buffer_load_dwordx4 a[224:227], v4, s[8:11], s26 offen sc1
    ds_read_b64_tr_b16 a[210:211], v8 offset:55808
    v_mfma_f32_16x16x32_bf16 v[52:55], a[52:55], v[44:47], v[52:55]
    ds_read_b64_tr_b16 a[216:217], v8 offset:16384
    ds_read_b64_tr_b16 a[218:219], v8 offset:16896
    v_mfma_f32_16x16x32_bf16 v[52:55], a[64:67], v[28:31], v[52:55]
    ds_read_b64_tr_b16 a[220:221], v8 offset:57344
    ds_read_b64_tr_b16 a[222:223], v8 offset:57856
    v_mfma_f32_16x16x32_bf16 v[56:59], a[56:59], v[44:47], v[56:59]
    ds_read_b128 v[44:47], v11 offset:24576
    s_add_u32 s26, s26, 1024
    s_cmp_eq_u32 s26, s25
    v_mfma_f32_16x16x32_bf16 v[56:59], a[68:71], v[28:31], v[56:59]
    ds_read_b128 v[28:31], v12 offset:0
    s_cselect_b32 s26, s24, s26
    s_waitcnt lgkmcnt(9)
    v_mfma_f32_16x16x32_bf16 v[48:51], a[72:75], v[32:35], v[48:51]
    buffer_load_dwordx4 a[236:239], v4, s[8:11], s26 offen sc1
    ds_read_b64_tr_b16 a[228:229], v8 offset:18432
    v_mfma_f32_16x16x32_bf16 v[48:51], a[84:87], v[36:39], v[48:51]
    ds_read_b64_tr_b16 a[230:231], v8 offset:18944
    ds_read_b64_tr_b16 a[232:233], v8 offset:59392
    v_mfma_f32_16x16x32_bf16 v[52:55], a[76:79], v[32:35], v[52:55]
    ds_read_b64_tr_b16 a[234:235], v8 offset:59904
    s_add_u32 s1, s0, 0
    v_mfma_f32_16x16x32_bf16 v[52:55], a[88:91], v[36:39], v[52:55]
    buffer_load_dwordx4 v[120:123], v4, s[8:11], s1 offen offset:0 sc1
    v_mfma_f32_16x16x32_bf16 v[56:59], a[80:83], v[32:35], v[56:59]
    ds_read_b128 v[32:35], v12 offset:1024
    v_lshlrev_b32 v6, 9, v3
    v_mfma_f32_16x16x32_bf16 v[56:59], a[92:95], v[36:39], v[56:59]
    ds_read_b128 v[36:39], v12 offset:2048
    s_waitcnt lgkmcnt(7)
    v_mfma_f32_16x16x32_bf16 v[48:51], a[96:99], v[40:43], v[48:51]
    v_min_u32 v116, 39, v1
    v_mul_u32_u24 v117, 6554, v116
    v_mfma_f32_16x16x32_bf16 v[48:51], a[108:111], v[44:47], v[48:51]
    buffer_load_dwordx4 v[124:127], v4, s[8:11], s1 offen offset:1024 sc1
    v_mfma_f32_16x16x32_bf16 v[52:55], a[100:103], v[40:43], v[52:55]
    v_lshrrev_b32 v117, 16, v117
    v_mul_u32_u24 v26, 10, v117
    v_mfma_f32_16x16x32_bf16 v[52:55], a[112:115], v[44:47], v[52:55]
    v_sub_u32 v116, v116, v26
    s_waitcnt vmcnt(21)
    v_mfma_f32_16x16x32_bf16 v[56:59], a[104:107], v[40:43], v[56:59]
    ds_read_b128 v[40:43], v12 offset:3072
    v_mov_b32 v118, v116
    v_mfma_f32_16x16x32_bf16 v[56:59], a[116:119], v[44:47], v[56:59]
    ds_read_b128 v[44:47], v12 offset:4096
    buffer_load_dwordx4 v[128:131], v4, s[8:11], s1 offen offset:2048 sc1
    s_waitcnt lgkmcnt(3)
    v_mfma_f32_16x16x32_bf16 v[48:51], a[120:123], v[28:31], v[48:51]
    s_waitcnt vmcnt(7)
    v_max3_u32 v106, v96, v97, v101
    v_mfma_f32_16x16x32_bf16 v[48:51], a[132:135], v[32:35], v[48:51]
    v_max_u32 v106, v106, v102
    v_lshlrev_b32 v7, 8, v118
    v_mfma_f32_16x16x32_bf16 v[52:55], a[124:127], v[28:31], v[52:55]
    v_cmp_eq_u32 vcc, -1, v106
    s_cbranch_vccnz RT_ss
BK_ss:
    v_mfma_f32_16x16x32_bf16 v[52:55], a[136:139], v[32:35], v[52:55]
    v_mov_b32 v107, 1.0
    v_add_f32 v96, v96, v97
    v_mfma_f32_16x16x32_bf16 v[56:59], a[128:131], v[28:31], v[56:59]
    ds_read_b128 v[28:31], v12 offset:20480
    buffer_load_dwordx4 v[132:135], v4, s[8:11], s1 offen offset:3072 sc1
    v_mfma_f32_16x16x32_bf16 v[56:59], a[140:143], v[32:35], v[56:59]
    ds_read_b128 v[32:35], v12 offset:21504
    s_waitcnt lgkmcnt(3)
    v_mfma_f32_16x16x32_bf16 v[48:51], a[144:147], v[36:39], v[48:51]
    v_add_f32 v101, v101, v102
    v_mov_b32 v106, 0x3727c5ac
    v_mfma_f32_16x16x32_bf16 v[48:51], a[156:159], v[40:43], v[48:51]
    s_add_u32 s1, s0, 4096
    s_mov_b32 s49, 0x3acccccd
    v_mfma_f32_16x16x32_bf16 v[52:55], a[148:151], v[36:39], v[52:55]
    buffer_load_dwordx4 v[136:139], v4, s[8:11], s1 offen offset:0 sc1
    v_mfma_f32_16x16x32_bf16 v[52:55], a[160:163], v[40:43], v[52:55]
    v_lshl_add_u32 v7, v117, 4, v7
    v_mul_u32_u24 v8, 40960, v117
    v_mfma_f32_16x16x32_bf16 v[56:59], a[152:155], v[36:39], v[56:59]
    v_mfma_f32_16x16x4_f32 v[108:111], v107, v96, 0
    v_mfma_f32_16x16x4_f32 v[112:115], v107, v101, 0
    ds_read_b128 v[36:39], v12 offset:22528
    v_mfma_f32_16x16x32_bf16 v[56:59], a[164:167], v[40:43], v[56:59]
    ds_read_b128 v[40:43], v12 offset:23552
    s_add_u32 s1, s0, 40960
    s_waitcnt lgkmcnt(3)
    v_mfma_f32_16x16x32_bf16 v[48:51], a[168:171], v[44:47], v[48:51]
    ds_read2st64_b32 v[72:73], v5 offset0:20 offset1:24
    ds_read2st64_b32 v[74:75], v5 offset0:28 offset1:32
    ds_read_b32 v76, v5 offset:9216
    v_mfma_f32_16x16x32_bf16 v[48:51], a[180:183], v[28:31], v[48:51]
    buffer_load_dwordx4 v[140:143], v4, s[8:11], s1 offen offset:0 sc1
    v_mfma_f32_16x16x32_bf16 v[52:55], a[172:175], v[44:47], v[52:55]
    v_lshl_add_u32 v8, v118, 4, v8
    v_fma_f32 v109, v108, s49, v106
    v_mfma_f32_16x16x32_bf16 v[52:55], a[184:187], v[28:31], v[52:55]
    v_cmp_gt_u32 vcc, 40, v1
    v_mov_b32 v26, 1073741824
    v_mfma_f32_16x16x32_bf16 v[56:59], a[176:179], v[44:47], v[56:59]
    ds_read_b128 v[44:47], v12 offset:24576
    v_mul_u32_u24 v9, 336, v117
    v_fma_f32 v113, v112, s49, v106
    v_mfma_f32_16x16x32_bf16 v[56:59], a[188:191], v[28:31], v[56:59]
    v_cndmask_b32 v8, v26, v8, vcc
    v_rsq_f32 v108, v109
    s_waitcnt lgkmcnt(5)
    v_mfma_f32_16x16x32_bf16 v[48:51], a[192:195], v[32:35], v[48:51]
    s_waitcnt lgkmcnt(1)
    v_max3_u32 v77, v72, v73, v74
    v_max3_u32 v77, v77, v75, v76
    v_cmp_eq_u32 vcc, -1, v77
    s_cbranch_vccnz RT_h1
BK_h1:
    v_mfma_f32_16x16x32_bf16 v[48:51], a[204:207], v[36:39], v[48:51]
    v_rsq_f32 v112, v113
    s_lshl_b32 s3, s28, 8
    v_add_u32 v107, s3, v14
    v_mul_f32 v109, v109, v108
    v_mul_f32 v113, v113, v112
    v_mul_f32 v108, 0xbfb8aa3b, v108
    v_mul_f32 v112, 0xbfb8aa3b, v112
    ds_write_b64 v107, v[108:109] offset:0
    ds_write_b64 v107, v[112:113] offset:128
    v_mfma_f32_16x16x32_bf16 v[52:55], a[196:199], v[32:35], v[52:55]
    s_add_u32 m0, s36, 10240
    v_add_u32 v0, 655360, v4
    buffer_load_dwordx4 v0, s[8:11], s29 offen offset:0 sc1 lds
    v_mfma_f32_16x16x32_bf16 v[52:55], a[208:211], v[36:39], v[52:55]
    v_mov_b32 v92, -1
    s_waitcnt lgkmcnt(0)
    s_barrier
    s_waitcnt vmcnt(9)
    v_mfma_f32_16x16x32_bf16 v[56:59], a[200:203], v[32:35], v[56:59]
    ds_read_b128 v[28:31], v11 offset:5120
    v_lshl_add_u32 v9, v116, 5, v9
    v_mfma_f32_16x16x32_bf16 v[56:59], a[212:215], v[36:39], v[56:59]
    ds_read_b128 v[32:35], v11 offset:6144
    buffer_load_dwordx4 v0, s[8:11], s30 offen offset:1024 sc1 lds
    v_mfma_f32_16x16x32_bf16 v[48:51], a[216:219], v[40:43], v[48:51]
    v_mov_b32 v93, -1
    ds_read_b128 v[36:39], v11 offset:7168
    v_mfma_f32_16x16x32_bf16 v[48:51], a[228:231], v[44:47], v[48:51]
    v_add_u32 v9, s46, v9
    v_mov_b32 v94, -1
    v_mfma_f32_16x16x32_bf16 v[52:55], a[220:223], v[40:43], v[52:55]
    buffer_load_dwordx4 v0, s[8:11], s31 offen offset:2048 sc1 lds
    v_mfma_f32_16x16x32_bf16 v[52:55], a[232:235], v[44:47], v[52:55]
    v_lshlrev_b32 v10, 4, v117
    s_waitcnt vmcnt(9)
    v_mfma_f32_16x16x32_bf16 v[56:59], a[224:227], v[40:43], v[56:59]
    v_mov_b32 v95, -1
    ds_read_b64 v[24:25], v14 offset:0
    v_mfma_f32_16x16x32_bf16 v[56:59], a[236:239], v[44:47], v[56:59]
    ds_read_b128 v[40:43], v11 offset:8192
    s_waitcnt lgkmcnt(3)
    v_mfma_f32_16x16x32_bf16 v[60:63], a[0:3], v[28:31], 0
    buffer_load_dwordx4 v0, s[8:11], s37 offen offset:3072 sc1 lds
    v_mfma_f32_16x16x32_bf16 v[60:63], a[12:15], v[32:35], v[60:63]
    ds_read_b128 v[44:47], v11 offset:9216
    v_mfma_f32_16x16x32_bf16 v[64:67], a[4:7], v[28:31], 0
    s_add_u32 m0, s36, 14336
    v_mfma_f32_16x16x32_bf16 v[64:67], a[16:19], v[32:35], v[64:67]
    buffer_load_dwordx4 v0, s[8:11], s48 offen offset:0 sc1 lds
    v_mfma_f32_16x16x32_bf16 v[68:71], a[8:11], v[28:31], 0
    ds_read_b128 v[28:31], v11 offset:25600
    s_waitcnt lgkmcnt(3)
    v_mfma_f32_16x16x32_bf16 v[68:71], a[20:23], v[32:35], v[68:71]
    ds_read_b128 v[32:35], v11 offset:26624
    s_waitcnt lgkmcnt(3)
    v_mfma_f32_16x16x32_bf16 v[60:63], a[24:27], v[36:39], v[60:63]
    s_add_u32 m0, s36, 0
    v_add_u32 v0, 983040, v4
    v_mul_f32 v48, v48, v24
    v_mfma_f32_16x16x32_bf16 v[60:63], a[36:39], v[40:43], v[60:63]
    buffer_load_dwordx4 v0, s[8:11], s29 offen offset:0 sc1 lds
    v_mul_f32 v49, v49, v24
    v_mfma_f32_16x16x32_bf16 v[64:67], a[28:31], v[36:39], v[64:67]
    v_exp_f32 v48, v48
    v_mfma_f32_16x16x32_bf16 v[64:67], a[40:43], v[40:43], v[64:67]
    v_mul_f32 v50, v50, v24
    v_mul_f32 v51, v51, v24
    v_mfma_f32_16x16x32_bf16 v[68:71], a[32:35], v[36:39], v[68:71]
    ds_read_b128 v[36:39], v11 offset:27648
    buffer_load_dwordx4 v0, s[8:11], s30 offen offset:1024 sc1 lds
    v_mfma_f32_16x16x32_bf16 v[68:71], a[44:47], v[40:43], v[68:71]
    ds_read_b128 v[40:43], v11 offset:28672
    v_exp_f32 v49, v49
    s_waitcnt lgkmcnt(3)
    v_mfma_f32_16x16x32_bf16 v[60:63], a[48:51], v[44:47], v[60:63]
    v_mul_f32 v56, v56, v24
    v_mul_f32 v57, v57, v24
    v_mfma_f32_16x16x32_bf16 v[60:63], a[60:63], v[28:31], v[60:63]
    buffer_load_dwordx4 v0, s[8:11], s31 offen offset:2048 sc1 lds
    v_mfma_f32_16x16x32_bf16 v[64:67], a[52:55], v[44:47], v[64:67]
    v_exp_f32 v50, v50
    v_mfma_f32_16x16x32_bf16 v[64:67], a[64:67], v[28:31], v[64:67]
    v_fma_f32 v48, v48, v25, v25
    v_fma_f32 v49, v49, v25, v25
    v_mfma_f32_16x16x32_bf16 v[68:71], a[56:59], v[44:47], v[68:71]
    ds_read_b128 v[44:47], v11 offset:29696
    v_fma_f32 v50, v50, v25, v25
    v_exp_f32 v51, v51
    v_mfma_f32_16x16x32_bf16 v[68:71], a[68:71], v[28:31], v[68:71]
    ds_read_b128 v[28:31], v12 offset:5120
    buffer_load_dwordx4 v0, s[8:11], s37 offen offset:3072 sc1 lds
    s_waitcnt lgkmcnt(3)
    v_mfma_f32_16x16x32_bf16 v[60:63], a[72:75], v[32:35], v[60:63]
    v_exp_f32 v56, v56
    v_mfma_f32_16x16x32_bf16 v[60:63], a[84:87], v[36:39], v[60:63]
    s_add_u32 m0, s36, 4096
    v_fma_f32 v51, v51, v25, v25
    v_mfma_f32_16x16x32_bf16 v[64:67], a[76:79], v[32:35], v[64:67]
    buffer_load_dwordx4 v0, s[8:11], s48 offen offset:0 sc1 lds
    v_mfma_f32_16x16x32_bf16 v[64:67], a[88:91], v[36:39], v[64:67]
    v_exp_f32 v57, v57
    v_mfma_f32_16x16x32_bf16 v[68:71], a[80:83], v[32:35], v[68:71]
    ds_read_b128 v[32:35], v12 offset:6144
    v_fma_f32 v56, v56, v25, v25
    v_mfma_f32_16x16x32_bf16 v[68:71], a[92:95], v[36:39], v[68:71]
    ds_read_b128 v[36:39], v12 offset:7168
    v_rcp_f32 v48, v48
    s_waitcnt lgkmcnt(3)
    v_mfma_f32_16x16x32_bf16 v[60:63], a[96:99], v[40:43], v[60:63]
    buffer_load_dwordx4 v[144:147], v4, s[8:11], s1 offen offset:1024 sc1
    v_mfma_f32_16x16x32_bf16 v[60:63], a[108:111], v[44:47], v[60:63]
    v_rcp_f32 v49, v49
    v_mfma_f32_16x16x32_bf16 v[64:67], a[100:103], v[40:43], v[64:67]
    v_fma_f32 v57, v57, v25, v25
    v_mul_f32 v48, v48, v52
    v_mfma_f32_16x16x32_bf16 v[64:67], a[112:115], v[44:47], v[64:67]
    v_rcp_f32 v50, v50
    v_mfma_f32_16x16x32_bf16 v[68:71], a[104:107], v[40:43], v[68:71]
    ds_read_b128 v[40:43], v12 offset:8192
    buffer_load_dwordx4 v[148:151], v4, s[8:11], s1 offen offset:2048 sc1
    v_mfma_f32_16x16x32_bf16 v[68:71], a[116:119], v[44:47], v[68:71]
    ds_read_b128 v[44:47], v12 offset:9216
    s_waitcnt lgkmcnt(3)
    v_mfma_f32_16x16x32_bf16 v[60:63], a[120:123], v[28:31], v[60:63]
    v_rcp_f32 v51, v51
    v_mfma_f32_16x16x32_bf16 v[60:63], a[132:135], v[32:35], v[60:63]
    v_mul_f32 v49, v49, v53
    v_mul_f32 v50, v50, v54
    v_mfma_f32_16x16x32_bf16 v[64:67], a[124:127], v[28:31], v[64:67]
    buffer_load_dwordx4 v[152:155], v4, s[8:11], s1 offen offset:3072 sc1
    v_rcp_f32 v56, v56
    v_mfma_f32_16x16x32_bf16 v[64:67], a[136:139], v[32:35], v[64:67]
    v_rcp_f32 v57, v57
    v_mfma_f32_16x16x32_bf16 v[68:71], a[128:131], v[28:31], v[68:71]
    ds_read_b128 v[28:31], v12 offset:25600
    v_mul_f32 v51, v51, v55
    v_mfma_f32_16x16x32_bf16 v[68:71], a[140:143], v[32:35], v[68:71]
    ds_read_b128 v[32:35], v12 offset:26624
    s_add_u32 s1, s0, 45056
    s_waitcnt lgkmcnt(3)
    v_mfma_f32_16x16x32_bf16 v[60:63], a[144:147], v[36:39], v[60:63]
    buffer_load_dwordx4 v[156:159], v4, s[8:11], s1 offen offset:0 sc1
    v_mfma_f32_16x16x32_bf16 v[60:63], a[156:159], v[40:43], v[60:63]
    v_cvt_pk_bf16_f32 v20, v48, v49
    v_mul_f32 v56, v56, v58
    v_mfma_f32_16x16x32_bf16 v[64:67], a[148:151], v[36:39], v[64:67]
    v_cvt_pk_bf16_f32 v21, v50, v51
    v_mul_f32 v57, v57, v59
    v_mfma_f32_16x16x32_bf16 v[64:67], a[160:163], v[40:43], v[64:67]
    v_cvt_pk_bf16_f32 v16, v48, v49
    v_cvt_pk_bf16_f32 v22, v56, v57
    v_mfma_f32_16x16x32_bf16 v[68:71], a[152:155], v[36:39], v[68:71]
    ds_read_b128 v[36:39], v12 offset:27648
    s_add_u32 s1, s0, 81920
    v_mfma_f32_16x16x32_bf16 v[68:71], a[164:167], v[40:43], v[68:71]
    ds_read_b128 v[40:43], v12 offset:28672
    buffer_load_dwordx4 v[160:163], v4, s[8:11], s1 offen offset:0 sc1
    s_waitcnt lgkmcnt(3)
    v_mfma_f32_16x16x32_bf16 v[60:63], a[168:171], v[44:47], v[60:63]
    v_permlane16_swap_b32 v20, v21
    v_mfma_f32_16x16x32_bf16 v[60:63], a[180:183], v[28:31], v[60:63]
    v_cvt_pk_bf16_f32 v17, v50, v51
    v_cvt_pk_bf16_f32 v18, v56, v57
    v_permlane16_swap_b32 v22, v19
    v_mfma_f32_16x16x32_bf16 v[64:67], a[172:175], v[44:47], v[64:67]
    s_add_u32 s49, s45, 0
    v_mfma_f32_16x16x32_bf16 v[64:67], a[184:187], v[28:31], v[64:67]
    buffer_load_dwordx4 v[164:167], v4, s[8:11], s1 offen offset:1024 sc1
    v_mfma_f32_16x16x32_bf16 v[68:71], a[176:179], v[44:47], v[68:71]
    ds_read_b128 v[44:47], v12 offset:29696
    v_permlane32_swap_b32 v21, v19
    v_mfma_f32_16x16x32_bf16 v[68:71], a[188:191], v[28:31], v[68:71]
    buffer_store_dwordx4 v[16:19], v13, s[8:11], s49 offen sc1
    s_waitcnt lgkmcnt(2)
    v_mfma_f32_16x16x32_bf16 v[60:63], a[192:195], v[32:35], v[60:63]
    v_mfma_f32_16x16x32_bf16 v[60:63], a[204:207], v[36:39], v[60:63]
    v_mfma_f32_16x16x32_bf16 v[64:67], a[196:199], v[32:35], v[64:67]
    s_waitcnt lgkmcnt(0)
    s_waitcnt vmcnt(12)
    s_barrier
    v_mfma_f32_16x16x32_bf16 v[64:67], a[208:211], v[36:39], v[64:67]
    ds_read_b128 v[28:31], v11 offset:10240
    v_mfma_f32_16x16x32_bf16 v[68:71], a[200:203], v[32:35], v[68:71]
    ds_read_b128 v[32:35], v11 offset:11264
    v_mfma_f32_16x16x32_bf16 v[68:71], a[212:215], v[36:39], v[68:71]
    ds_read_b128 v[36:39], v11 offset:12288
    v_mfma_f32_16x16x32_bf16 v[60:63], a[216:219], v[40:43], v[60:63]
    s_add_u32 m0, s36, 5120
    v_add_u32 v0, 1310720, v4
    v_mfma_f32_16x16x32_bf16 v[60:63], a[228:231], v[44:47], v[60:63]
    buffer_load_dwordx4 v0, s[8:11], s29 offen offset:0 sc1 lds
    v_mfma_f32_16x16x32_bf16 v[64:67], a[220:223], v[40:43], v[64:67]
    ds_read_b64 v[24:25], v14 offset:128
    v_mfma_f32_16x16x32_bf16 v[64:67], a[232:235], v[44:47], v[64:67]
    v_mfma_f32_16x16x32_bf16 v[68:71], a[224:227], v[40:43], v[68:71]
    ds_read_b128 v[40:43], v11 offset:13312
    v_mfma_f32_16x16x32_bf16 v[68:71], a[236:239], v[44:47], v[68:71]
    buffer_load_dwordx4 v0, s[8:11], s30 offen offset:1024 sc1 lds
    s_waitcnt lgkmcnt(3)
    v_mfma_f32_16x16x32_bf16 v[48:51], a[0:3], v[28:31], 0
    ds_read_b128 v[44:47], v11 offset:14336
    v_mfma_f32_16x16x32_bf16 v[48:51], a[12:15], v[32:35], v[48:51]
    v_mfma_f32_16x16x32_bf16 v[52:55], a[4:7], v[28:31], 0
    buffer_load_dwordx4 v0, s[8:11], s31 offen offset:2048 sc1 lds
    v_mfma_f32_16x16x32_bf16 v[52:55], a[16:19], v[32:35], v[52:55]
    s_waitcnt lgkmcnt(2)
    v_mul_f32 v60, v60, v24
    v_mfma_f32_16x16x32_bf16 v[56:59], a[8:11], v[28:31], 0
    ds_read_b128 v[28:31], v11 offset:30720
    v_mul_f32 v61, v61, v24
    v_mfma_f32_16x16x32_bf16 v[56:59], a[20:23], v[32:35], v[56:59]
    ds_read_b128 v[32:35], v11 offset:31744
    buffer_load_dwordx4 v0, s[8:11], s37 offen offset:3072 sc1 lds
    s_waitcnt lgkmcnt(3)
    v_mfma_f32_16x16x32_bf16 v[48:51], a[24:27], v[36:39], v[48:51]
    v_exp_f32 v60, v60
    v_mfma_f32_16x16x32_bf16 v[48:51], a[36:39], v[40:43], v[48:51]
    v_mul_f32 v62, v62, v24
    v_mul_f32 v63, v63, v24
    v_mfma_f32_16x16x32_bf16 v[52:55], a[28:31], v[36:39], v[52:55]
    s_add_u32 m0, s36, 9216
    v_mul_f32 v68, v68, v24
    v_mfma_f32_16x16x32_bf16 v[52:55], a[40:43], v[40:43], v[52:55]
    buffer_load_dwordx4 v0, s[8:11], s48 offen offset:0 sc1 lds
    v_mfma_f32_16x16x32_bf16 v[56:59], a[32:35], v[36:39], v[56:59]
    ds_read_b128 v[36:39], v11 offset:32768
    v_mul_f32 v69, v69, v24
    v_mfma_f32_16x16x32_bf16 v[56:59], a[44:47], v[40:43], v[56:59]
    ds_read_b128 v[40:43], v11 offset:33792
    s_add_u32 s3, s45, 4718592
    s_waitcnt lgkmcnt(3)
    v_mfma_f32_16x16x32_bf16 v[48:51], a[48:51], v[44:47], v[48:51]
    buffer_store_dwordx4 v[92:95], v13, s[8:11], s3 offen sc1
    v_exp_f32 v61, v61
    v_mfma_f32_16x16x32_bf16 v[48:51], a[60:63], v[28:31], v[48:51]
    v_exp_f32 v62, v62
    v_mfma_f32_16x16x32_bf16 v[52:55], a[52:55], v[44:47], v[52:55]
    v_fma_f32 v60, v60, v25, v25
    v_fma_f32 v61, v61, v25, v25
    v_mfma_f32_16x16x32_bf16 v[52:55], a[64:67], v[28:31], v[52:55]
    v_exp_f32 v63, v63
    v_mfma_f32_16x16x32_bf16 v[56:59], a[56:59], v[44:47], v[56:59]
    ds_read_b128 v[44:47], v11 offset:34816
    v_fma_f32 v62, v62, v25, v25
    v_mfma_f32_16x16x32_bf16 v[56:59], a[68:71], v[28:31], v[56:59]
    ds_read_b128 v[28:31], v12 offset:10240
    s_add_u32 s3, s45, 5505024
    s_waitcnt lgkmcnt(3)
    v_mfma_f32_16x16x32_bf16 v[48:51], a[72:75], v[32:35], v[48:51]
    buffer_store_dwordx4 v[92:95], v13, s[8:11], s3 offen sc1
    v_exp_f32 v68, v68
    v_mfma_f32_16x16x32_bf16 v[48:51], a[84:87], v[36:39], v[48:51]
    v_exp_f32 v69, v69
    v_mfma_f32_16x16x32_bf16 v[52:55], a[76:79], v[32:35], v[52:55]
    v_fma_f32 v63, v63, v25, v25
    v_fma_f32 v68, v68, v25, v25
    v_mfma_f32_16x16x32_bf16 v[52:55], a[88:91], v[36:39], v[52:55]
    v_rcp_f32 v60, v60
    v_mfma_f32_16x16x32_bf16 v[56:59], a[80:83], v[32:35], v[56:59]
    ds_read_b128 v[32:35], v12 offset:11264
    v_fma_f32 v69, v69, v25, v25
    v_mfma_f32_16x16x32_bf16 v[56:59], a[92:95], v[36:39], v[56:59]
    ds_read_b128 v[36:39], v12 offset:12288
    s_waitcnt lgkmcnt(3)
    v_mfma_f32_16x16x32_bf16 v[48:51], a[96:99], v[40:43], v[48:51]
    buffer_load_dwordx4 v[168:171], v4, s[8:11], s1 offen offset:2048 sc1
    v_mfma_f32_16x16x32_bf16 v[48:51], a[108:111], v[44:47], v[48:51]
    v_rcp_f32 v61, v61
    v_mfma_f32_16x16x32_bf16 v[52:55], a[100:103], v[40:43], v[52:55]
    v_rcp_f32 v62, v62
    v_mfma_f32_16x16x32_bf16 v[52:55], a[112:115], v[44:47], v[52:55]
    v_mul_f32 v60, v60, v64
    v_mul_f32 v61, v61, v65
    v_mfma_f32_16x16x32_bf16 v[56:59], a[104:107], v[40:43], v[56:59]
    ds_read_b128 v[40:43], v12 offset:13312
    v_mul_f32 v62, v62, v66
    v_mfma_f32_16x16x32_bf16 v[56:59], a[116:119], v[44:47], v[56:59]
    ds_read_b128 v[44:47], v12 offset:14336
    buffer_load_dwordx4 v[172:175], v4, s[8:11], s1 offen offset:3072 sc1
    s_waitcnt lgkmcnt(3)
    v_mfma_f32_16x16x32_bf16 v[48:51], a[120:123], v[28:31], v[48:51]
    v_rcp_f32 v63, v63
    v_mfma_f32_16x16x32_bf16 v[48:51], a[132:135], v[32:35], v[48:51]
    v_rcp_f32 v68, v68
    v_mfma_f32_16x16x32_bf16 v[52:55], a[124:127], v[28:31], v[52:55]
    s_add_u32 s1, s0, 86016
    v_mul_f32 v63, v63, v67
    v_mfma_f32_16x16x32_bf16 v[52:55], a[136:139], v[32:35], v[52:55]
    buffer_load_dwordx4 v[176:179], v4, s[8:11], s1 offen offset:0 sc1
    v_mfma_f32_16x16x32_bf16 v[56:59], a[128:131], v[28:31], v[56:59]
    ds_read_b128 v[28:31], v12 offset:30720
    v_cvt_pk_bf16_f32 v20, v60, v61
    v_rcp_f32 v69, v69
    v_mfma_f32_16x16x32_bf16 v[56:59], a[140:143], v[32:35], v[56:59]
    ds_read_b128 v[32:35], v12 offset:31744
    s_waitcnt lgkmcnt(3)
    v_mfma_f32_16x16x32_bf16 v[48:51], a[144:147], v[36:39], v[48:51]
    s_add_u32 s1, s0, 122880
    v_mul_f32 v68, v68, v70
    v_mfma_f32_16x16x32_bf16 v[48:51], a[156:159], v[40:43], v[48:51]
    buffer_load_dwordx4 v[180:183], v4, s[8:11], s1 offen offset:0 sc1
    v_mfma_f32_16x16x32_bf16 v[52:55], a[148:151], v[36:39], v[52:55]
    v_cvt_pk_bf16_f32 v21, v62, v63
    v_mul_f32 v69, v69, v71
    v_mfma_f32_16x16x32_bf16 v[52:55], a[160:163], v[40:43], v[52:55]
    v_cvt_pk_bf16_f32 v16, v60, v61
    v_cvt_pk_bf16_f32 v22, v68, v69
    v_mfma_f32_16x16x32_bf16 v[56:59], a[152:155], v[36:39], v[56:59]
    ds_read_b128 v[36:39], v12 offset:32768
    v_cvt_pk_bf16_f32 v17, v62, v63
    v_mfma_f32_16x16x32_bf16 v[56:59], a[164:167], v[40:43], v[56:59]
    ds_read_b128 v[40:43], v12 offset:33792
    buffer_load_dwordx4 v[184:187], v4, s[8:11], s1 offen offset:1024 sc1
    s_waitcnt lgkmcnt(3)
    v_mfma_f32_16x16x32_bf16 v[48:51], a[168:171], v[44:47], v[48:51]
    v_permlane16_swap_b32 v20, v21
    v_mfma_f32_16x16x32_bf16 v[48:51], a[180:183], v[28:31], v[48:51]
    v_permlane16_swap_b32 v22, v19
    v_mfma_f32_16x16x32_bf16 v[52:55], a[172:175], v[44:47], v[52:55]
    v_cvt_pk_bf16_f32 v18, v68, v69
    s_add_u32 s49, s45, 786432
    v_mfma_f32_16x16x32_bf16 v[52:55], a[184:187], v[28:31], v[52:55]
    v_permlane32_swap_b32 v21, v19
    v_mfma_f32_16x16x32_bf16 v[56:59], a[176:179], v[44:47], v[56:59]
    ds_read_b128 v[44:47], v12 offset:34816
    buffer_load_dwordx4 v[188:191], v4, s[8:11], s1 offen offset:2048 sc1
    v_mfma_f32_16x16x32_bf16 v[56:59], a[188:191], v[28:31], v[56:59]
    buffer_store_dwordx4 v[16:19], v13, s[8:11], s49 offen sc1
    s_waitcnt lgkmcnt(2)
    v_mfma_f32_16x16x32_bf16 v[48:51], a[192:195], v[32:35], v[48:51]
    v_mfma_f32_16x16x32_bf16 v[48:51], a[204:207], v[36:39], v[48:51]
    v_mfma_f32_16x16x32_bf16 v[52:55], a[196:199], v[32:35], v[52:55]
    s_waitcnt lgkmcnt(0)
    s_waitcnt vmcnt(21)
    s_barrier
    v_mfma_f32_16x16x32_bf16 v[52:55], a[208:211], v[36:39], v[52:55]
    ds_read_b128 v[28:31], v11 offset:0
    v_mfma_f32_16x16x32_bf16 v[56:59], a[200:203], v[32:35], v[56:59]
    ds_read_b128 v[32:35], v11 offset:1024
    v_mfma_f32_16x16x32_bf16 v[56:59], a[212:215], v[36:39], v[56:59]
    ds_read_b128 v[36:39], v11 offset:2048
    v_mfma_f32_16x16x32_bf16 v[48:51], a[216:219], v[40:43], v[48:51]
    v_mfma_f32_16x16x32_bf16 v[48:51], a[228:231], v[44:47], v[48:51]
    s_add_u32 m0, s36, 10240
    v_add_u32 v0, 1638400, v4
    v_mfma_f32_16x16x32_bf16 v[52:55], a[220:223], v[40:43], v[52:55]
    buffer_load_dwordx4 v0, s[8:11], s29 offen offset:0 sc1 lds
    v_mfma_f32_16x16x32_bf16 v[52:55], a[232:235], v[44:47], v[52:55]
    ds_read_b64 v[24:25], v14 offset:256
    v_mfma_f32_16x16x32_bf16 v[56:59], a[224:227], v[40:43], v[56:59]
    ds_read_b128 v[40:43], v11 offset:3072
    v_mfma_f32_16x16x32_bf16 v[56:59], a[236:239], v[44:47], v[56:59]
    buffer_load_dwordx4 v0, s[8:11], s30 offen offset:1024 sc1 lds
    s_waitcnt lgkmcnt(3)
    v_mfma_f32_16x16x32_bf16 v[60:63], a[0:3], v[28:31], 0
    ds_read_b128 v[44:47], v11 offset:4096
    v_mfma_f32_16x16x32_bf16 v[60:63], a[12:15], v[32:35], v[60:63]
    v_mfma_f32_16x16x32_bf16 v[64:67], a[4:7], v[28:31], 0
    v_mfma_f32_16x16x32_bf16 v[64:67], a[16:19], v[32:35], v[64:67]
    buffer_load_dwordx4 v0, s[8:11], s31 offen offset:2048 sc1 lds
    v_mfma_f32_16x16x32_bf16 v[68:71], a[8:11], v[28:31], 0
    ds_read_b128 v[28:31], v11 offset:20480
    s_waitcnt lgkmcnt(3)
    v_mfma_f32_16x16x32_bf16 v[68:71], a[20:23], v[32:35], v[68:71]
    ds_read_b128 v[32:35], v11 offset:21504
    s_waitcnt lgkmcnt(3)
    v_mfma_f32_16x16x32_bf16 v[60:63], a[24:27], v[36:39], v[60:63]
    buffer_load_dwordx4 v0, s[8:11], s37 offen offset:3072 sc1 lds
    v_mul_f32 v48, v48, v24
    v_mfma_f32_16x16x32_bf16 v[60:63], a[36:39], v[40:43], v[60:63]
    v_mul_f32 v49, v49, v24
    v_mul_f32 v50, v50, v24
    v_mfma_f32_16x16x32_bf16 v[64:67], a[28:31], v[36:39], v[64:67]
    v_exp_f32 v48, v48
    v_mfma_f32_16x16x32_bf16 v[64:67], a[40:43], v[40:43], v[64:67]
    s_add_u32 m0, s36, 14336
    v_mul_f32 v51, v51, v24
    v_mfma_f32_16x16x32_bf16 v[68:71], a[32:35], v[36:39], v[68:71]
    ds_read_b128 v[36:39], v11 offset:22528
    buffer_load_dwordx4 v0, s[8:11], s48 offen offset:0 sc1 lds
    v_mfma_f32_16x16x32_bf16 v[68:71], a[44:47], v[40:43], v[68:71]
    ds_read_b128 v[40:43], v11 offset:23552
    v_exp_f32 v49, v49
    s_waitcnt lgkmcnt(3)
    v_mfma_f32_16x16x32_bf16 v[60:63], a[48:51], v[44:47], v[60:63]
    v_mul_f32 v56, v56, v24
    v_mul_f32 v57, v57, v24
    v_mfma_f32_16x16x32_bf16 v[60:63], a[60:63], v[28:31], v[60:63]
    buffer_load_dwordx4 v[192:195], v4, s[8:11], s1 offen offset:3072 sc1
    v_mfma_f32_16x16x32_bf16 v[64:67], a[52:55], v[44:47], v[64:67]
    v_exp_f32 v50, v50
    v_mfma_f32_16x16x32_bf16 v[64:67], a[64:67], v[28:31], v[64:67]
    v_fma_f32 v48, v48, v25, v25
    v_fma_f32 v49, v49, v25, v25
    v_mfma_f32_16x16x32_bf16 v[68:71], a[56:59], v[44:47], v[68:71]
    ds_read_b128 v[44:47], v11 offset:24576
    s_add_u32 s1, s0, 126976
    v_exp_f32 v51, v51
    v_mfma_f32_16x16x32_bf16 v[68:71], a[68:71], v[28:31], v[68:71]
    ds_read_b128 v[28:31], v12 offset:0
    buffer_load_dwordx4 v[196:199], v4, s[8:11], s1 offen offset:0 sc1
    s_waitcnt lgkmcnt(3)
    v_mfma_f32_16x16x32_bf16 v[60:63], a[72:75], v[32:35], v[60:63]
    v_exp_f32 v56, v56
    v_mfma_f32_16x16x32_bf16 v[60:63], a[84:87], v[36:39], v[60:63]
    v_fma_f32 v50, v50, v25, v25
    v_fma_f32 v51, v51, v25, v25
    v_mfma_f32_16x16x32_bf16 v[64:67], a[76:79], v[32:35], v[64:67]
    s_add_u32 s1, s0, 163840
    v_fma_f32 v56, v56, v25, v25
    v_mfma_f32_16x16x32_bf16 v[64:67], a[88:91], v[36:39], v[64:67]
    buffer_load_dwordx4 v[200:203], v4, s[8:11], s1 offen offset:0 sc1
    v_exp_f32 v57, v57
    v_mfma_f32_16x16x32_bf16 v[68:71], a[80:83], v[32:35], v[68:71]
    ds_read_b128 v[32:35], v12 offset:1024
    v_fma_f32 v57, v57, v25, v25
    v_mfma_f32_16x16x32_bf16 v[68:71], a[92:95], v[36:39], v[68:71]
    ds_read_b128 v[36:39], v12 offset:2048
    v_rcp_f32 v48, v48
    s_waitcnt lgkmcnt(3)
    v_mfma_f32_16x16x32_bf16 v[60:63], a[96:99], v[40:43], v[60:63]
    v_rcp_f32 v49, v49
    v_mfma_f32_16x16x32_bf16 v[60:63], a[108:111], v[44:47], v[60:63]
    v_rcp_f32 v50, v50
    v_mfma_f32_16x16x32_bf16 v[64:67], a[100:103], v[40:43], v[64:67]
    buffer_load_dwordx4 v[204:207], v4, s[8:11], s1 offen offset:1024 sc1
    v_mfma_f32_16x16x32_bf16 v[64:67], a[112:115], v[44:47], v[64:67]
    v_mul_f32 v48, v48, v52
    v_mul_f32 v49, v49, v53
    v_mfma_f32_16x16x32_bf16 v[68:71], a[104:107], v[40:43], v[68:71]
    ds_read_b128 v[40:43], v12 offset:3072
    v_mul_f32 v50, v50, v54
    v_mfma_f32_16x16x32_bf16 v[68:71], a[116:119], v[44:47], v[68:71]
    ds_read_b128 v[44:47], v12 offset:4096
    s_waitcnt lgkmcnt(3)
    v_mfma_f32_16x16x32_bf16 v[60:63], a[120:123], v[28:31], v[60:63]
    buffer_load_dwordx4 v[208:211], v4, s[8:11], s1 offen offset:2048 sc1
    v_rcp_f32 v51, v51
    v_mfma_f32_16x16x32_bf16 v[60:63], a[132:135], v[32:35], v[60:63]
    v_rcp_f32 v56, v56
    v_mfma_f32_16x16x32_bf16 v[64:67], a[124:127], v[28:31], v[64:67]
    v_rcp_f32 v57, v57
    v_mfma_f32_16x16x32_bf16 v[64:67], a[136:139], v[32:35], v[64:67]
    v_mul_f32 v51, v51, v55
    v_cvt_pk_bf16_f32 v20, v48, v49
    v_mfma_f32_16x16x32_bf16 v[68:71], a[128:131], v[28:31], v[68:71]
    ds_read_b128 v[28:31], v12 offset:20480
    buffer_load_dwordx4 v[212:215], v4, s[8:11], s1 offen offset:3072 sc1
    v_mfma_f32_16x16x32_bf16 v[68:71], a[140:143], v[32:35], v[68:71]
    ds_read_b128 v[32:35], v12 offset:21504
    s_waitcnt lgkmcnt(3)
    v_mfma_f32_16x16x32_bf16 v[60:63], a[144:147], v[36:39], v[60:63]
    v_mul_f32 v56, v56, v58
    v_cvt_pk_bf16_f32 v21, v50, v51
    v_mfma_f32_16x16x32_bf16 v[60:63], a[156:159], v[40:43], v[60:63]
    s_add_u32 s1, s0, 167936
    v_mul_f32 v57, v57, v59
    v_mfma_f32_16x16x32_bf16 v[64:67], a[148:151], v[36:39], v[64:67]
    buffer_load_dwordx4 v[216:219], v4, s[8:11], s1 offen offset:0 sc1
    v_mfma_f32_16x16x32_bf16 v[64:67], a[160:163], v[40:43], v[64:67]
    v_cvt_pk_bf16_f32 v16, v48, v49
    v_cvt_pk_bf16_f32 v22, v56, v57
    v_mfma_f32_16x16x32_bf16 v[68:71], a[152:155], v[36:39], v[68:71]
    ds_read_b128 v[36:39], v12 offset:22528
    v_cvt_pk_bf16_f32 v17, v50, v51
    v_mfma_f32_16x16x32_bf16 v[68:71], a[164:167], v[40:43], v[68:71]
    ds_read_b128 v[40:43], v12 offset:23552
    v_permlane16_swap_b32 v20, v21
    s_waitcnt lgkmcnt(3)
    v_mfma_f32_16x16x32_bf16 v[60:63], a[168:171], v[44:47], v[60:63]
    s_add_u32 s1, s0, 204800
    v_cvt_pk_bf16_f32 v18, v56, v57
    v_mfma_f32_16x16x32_bf16 v[60:63], a[180:183], v[28:31], v[60:63]
    buffer_load_dwordx4 v[220:223], v4, s[8:11], s1 offen offset:0 sc1
    v_permlane16_swap_b32 v22, v19
    v_mfma_f32_16x16x32_bf16 v[64:67], a[172:175], v[44:47], v[64:67]
    s_add_u32 s49, s45, 1572864
    v_mfma_f32_16x16x32_bf16 v[64:67], a[184:187], v[28:31], v[64:67]
    v_permlane32_swap_b32 v21, v19
    v_mfma_f32_16x16x32_bf16 v[68:71], a[176:179], v[44:47], v[68:71]
    ds_read_b128 v[44:47], v12 offset:24576
    v_mfma_f32_16x16x32_bf16 v[68:71], a[188:191], v[28:31], v[68:71]
    buffer_store_dwordx4 v[16:19], v13, s[8:11], s49 offen sc1
    s_waitcnt lgkmcnt(2)
    v_mfma_f32_16x16x32_bf16 v[60:63], a[192:195], v[32:35], v[60:63]
    v_mfma_f32_16x16x32_bf16 v[60:63], a[204:207], v[36:39], v[60:63]
    v_mfma_f32_16x16x32_bf16 v[64:67], a[196:199], v[32:35], v[64:67]
    s_waitcnt lgkmcnt(0)
    s_waitcnt vmcnt(14)
    s_barrier
    v_mfma_f32_16x16x32_bf16 v[64:67], a[208:211], v[36:39], v[64:67]
    ds_read_b128 v[28:31], v11 offset:5120
    v_mfma_f32_16x16x32_bf16 v[68:71], a[200:203], v[32:35], v[68:71]
    ds_read_b128 v[32:35], v11 offset:6144
    v_and_b32 v26, 31, v1
    v_mfma_f32_16x16x32_bf16 v[68:71], a[212:215], v[36:39], v[68:71]
    ds_read_b128 v[36:39], v11 offset:7168
    v_lshl_add_u32 v26, v26, 2, s42
    v_mfma_f32_16x16x32_bf16 v[60:63], a[216:219], v[40:43], v[60:63]
    buffer_store_dword v23, v26, s[8:11], 0 offen offset:0 sc1
    v_mfma_f32_16x16x32_bf16 v[60:63], a[228:231], v[44:47], v[60:63]
    s_add_u32 m0, s36, 0
    v_add_u32 v0, 1966080, v4
    buffer_load_dwordx4 v0, s[8:11], s29 offen offset:0 sc1 lds
    v_mfma_f32_16x16x32_bf16 v[64:67], a[220:223], v[40:43], v[64:67]
    ds_read_b64 v[24:25], v14 offset:384
    v_mfma_f32_16x16x32_bf16 v[64:67], a[232:235], v[44:47], v[64:67]
    v_mfma_f32_16x16x32_bf16 v[68:71], a[224:227], v[40:43], v[68:71]
    buffer_load_dwordx4 v0, s[8:11], s30 offen offset:1024 sc1 lds
    v_mfma_f32_16x16x32_bf16 v[68:71], a[236:239], v[44:47], v[68:71]
    ds_read_b128 v[40:43], v11 offset:8192
    s_waitcnt lgkmcnt(3)
    v_mfma_f32_16x16x32_bf16 v[48:51], a[0:3], v[28:31], 0
    ds_read_b128 v[44:47], v11 offset:9216
    v_mfma_f32_16x16x32_bf16 v[48:51], a[12:15], v[32:35], v[48:51]
    buffer_load_dwordx4 v0, s[8:11], s31 offen offset:2048 sc1 lds
    v_mfma_f32_16x16x32_bf16 v[52:55], a[4:7], v[28:31], 0
    v_mfma_f32_16x16x32_bf16 v[52:55], a[16:19], v[32:35], v[52:55]
    s_waitcnt lgkmcnt(2)
    v_mul_f32 v60, v60, v24
    v_mfma_f32_16x16x32_bf16 v[56:59], a[8:11], v[28:31], 0
    ds_read_b128 v[28:31], v11 offset:25600
    v_mul_f32 v61, v61, v24
    v_mfma_f32_16x16x32_bf16 v[56:59], a[20:23], v[32:35], v[56:59]
    ds_read_b128 v[32:35], v11 offset:26624
    buffer_load_dwordx4 v0, s[8:11], s37 offen offset:3072 sc1 lds
    s_waitcnt lgkmcnt(3)
    v_mfma_f32_16x16x32_bf16 v[48:51], a[24:27], v[36:39], v[48:51]
    v_exp_f32 v60, v60
    v_mfma_f32_16x16x32_bf16 v[48:51], a[36:39], v[40:43], v[48:51]
    s_add_u32 m0, s36, 4096
    v_mul_f32 v62, v62, v24
    v_mfma_f32_16x16x32_bf16 v[52:55], a[28:31], v[36:39], v[52:55]
    buffer_load_dwordx4 v0, s[8:11], s48 offen offset:0 sc1 lds
    v_mfma_f32_16x16x32_bf16 v[52:55], a[40:43], v[40:43], v[52:55]
    v_mul_f32 v63, v63, v24
    v_mul_f32 v68, v68, v24
    v_mfma_f32_16x16x32_bf16 v[56:59], a[32:35], v[36:39], v[56:59]
    ds_read_b128 v[36:39], v11 offset:27648
    v_mul_f32 v69, v69, v24
    v_mfma_f32_16x16x32_bf16 v[56:59], a[44:47], v[40:43], v[56:59]
    ds_read_b128 v[40:43], v11 offset:28672
    v_exp_f32 v61, v61
    s_waitcnt lgkmcnt(3)
    v_mfma_f32_16x16x32_bf16 v[48:51], a[48:51], v[44:47], v[48:51]
    buffer_load_dwordx4 v[224:227], v4, s[8:11], s1 offen offset:1024 sc1
    v_mfma_f32_16x16x32_bf16 v[48:51], a[60:63], v[28:31], v[48:51]
    v_exp_f32 v62, v62
    v_mfma_f32_16x16x32_bf16 v[52:55], a[52:55], v[44:47], v[52:55]
    v_fma_f32 v60, v60, v25, v25
    v_fma_f32 v61, v61, v25, v25
    v_mfma_f32_16x16x32_bf16 v[52:55], a[64:67], v[28:31], v[52:55]
    v_exp_f32 v63, v63
    v_mfma_f32_16x16x32_bf16 v[56:59], a[56:59], v[44:47], v[56:59]
    ds_read_b128 v[44:47], v11 offset:29696
    buffer_load_dwordx4 v[228:231], v4, s[8:11], s1 offen offset:2048 sc1
    v_mfma_f32_16x16x32_bf16 v[56:59], a[68:71], v[28:31], v[56:59]
    ds_read_b128 v[28:31], v12 offset:5120
    s_waitcnt lgkmcnt(3)
    v_mfma_f32_16x16x32_bf16 v[48:51], a[72:75], v[32:35], v[48:51]
    v_exp_f32 v68, v68
    v_mfma_f32_16x16x32_bf16 v[48:51], a[84:87], v[36:39], v[48:51]
    v_fma_f32 v62, v62, v25, v25
    v_fma_f32 v63, v63, v25, v25
    v_mfma_f32_16x16x32_bf16 v[52:55], a[76:79], v[32:35], v[52:55]
    buffer_load_dwordx4 v[232:235], v4, s[8:11], s1 offen offset:3072 sc1
    v_mfma_f32_16x16x32_bf16 v[52:55], a[88:91], v[36:39], v[52:55]
    v_exp_f32 v69, v69
    v_mfma_f32_16x16x32_bf16 v[56:59], a[80:83], v[32:35], v[56:59]
    ds_read_b128 v[32:35], v12 offset:6144
    v_fma_f32 v68, v68, v25, v25
    v_mfma_f32_16x16x32_bf16 v[56:59], a[92:95], v[36:39], v[56:59]
    ds_read_b128 v[36:39], v12 offset:7168
    s_add_u32 s1, s0, 208896
    s_waitcnt lgkmcnt(3)
    v_mfma_f32_16x16x32_bf16 v[48:51], a[96:99], v[40:43], v[48:51]
    buffer_load_dwordx4 v[236:239], v4, s[8:11], s1 offen offset:0 sc1
    v_rcp_f32 v60, v60
    v_mfma_f32_16x16x32_bf16 v[48:51], a[108:111], v[44:47], v[48:51]
    v_rcp_f32 v61, v61
    v_mfma_f32_16x16x32_bf16 v[52:55], a[100:103], v[40:43], v[52:55]
    v_fma_f32 v69, v69, v25, v25
    v_mul_f32 v60, v60, v64
    v_mfma_f32_16x16x32_bf16 v[52:55], a[112:115], v[44:47], v[52:55]
    v_rcp_f32 v62, v62
    v_mfma_f32_16x16x32_bf16 v[56:59], a[104:107], v[40:43], v[56:59]
    ds_read_b128 v[40:43], v12 offset:8192
    s_add_u32 s1, s0, 245760
    v_mfma_f32_16x16x32_bf16 v[56:59], a[116:119], v[44:47], v[56:59]
    ds_read_b128 v[44:47], v12 offset:9216
    buffer_load_dwordx4 v[240:243], v4, s[8:11], s1 offen offset:0 sc1
    s_waitcnt lgkmcnt(3)
    v_mfma_f32_16x16x32_bf16 v[48:51], a[120:123], v[28:31], v[48:51]
    v_rcp_f32 v63, v63
    v_mfma_f32_16x16x32_bf16 v[48:51], a[132:135], v[32:35], v[48:51]
    v_mul_f32 v61, v61, v65
    v_mul_f32 v62, v62, v66
    v_mfma_f32_16x16x32_bf16 v[52:55], a[124:127], v[28:31], v[52:55]
    v_rcp_f32 v68, v68
    v_mfma_f32_16x16x32_bf16 v[52:55], a[136:139], v[32:35], v[52:55]
    buffer_load_dwordx4 v[244:247], v4, s[8:11], s1 offen offset:1024 sc1
    v_mfma_f32_16x16x32_bf16 v[56:59], a[128:131], v[28:31], v[56:59]
    ds_read_b128 v[28:31], v12 offset:25600
    v_mul_f32 v63, v63, v67
    v_rcp_f32 v69, v69
    v_mfma_f32_16x16x32_bf16 v[56:59], a[140:143], v[32:35], v[56:59]
    ds_read_b128 v[32:35], v12 offset:26624
    s_waitcnt lgkmcnt(3)
    v_mfma_f32_16x16x32_bf16 v[48:51], a[144:147], v[36:39], v[48:51]
    v_cvt_pk_bf16_f32 v20, v60, v61
    v_mul_f32 v68, v68, v70
    v_mfma_f32_16x16x32_bf16 v[48:51], a[156:159], v[40:43], v[48:51]
    buffer_load_dwordx4 v[248:251], v4, s[8:11], s1 offen offset:2048 sc1
    v_mfma_f32_16x16x32_bf16 v[52:55], a[148:151], v[36:39], v[52:55]
    v_cvt_pk_bf16_f32 v21, v62, v63
    v_mul_f32 v69, v69, v71
    v_mfma_f32_16x16x32_bf16 v[52:55], a[160:163], v[40:43], v[52:55]
    v_cvt_pk_bf16_f32 v16, v60, v61
    v_cvt_pk_bf16_f32 v22, v68, v69
    v_mfma_f32_16x16x32_bf16 v[56:59], a[152:155], v[36:39], v[56:59]
    ds_read_b128 v[36:39], v12 offset:27648
    v_cvt_pk_bf16_f32 v17, v62, v63
    v_mfma_f32_16x16x32_bf16 v[56:59], a[164:167], v[40:43], v[56:59]
    ds_read_b128 v[40:43], v12 offset:28672
    buffer_load_dwordx4 v[252:255], v4, s[8:11], s1 offen offset:3072 sc1
    s_waitcnt lgkmcnt(3)
    v_mfma_f32_16x16x32_bf16 v[48:51], a[168:171], v[44:47], v[48:51]
    v_permlane16_swap_b32 v20, v21
    v_mfma_f32_16x16x32_bf16 v[48:51], a[180:183], v[28:31], v[48:51]
    v_permlane16_swap_b32 v22, v19
    v_mfma_f32_16x16x32_bf16 v[52:55], a[172:175], v[44:47], v[52:55]
    v_cvt_pk_bf16_f32 v18, v68, v69
    s_add_u32 s49, s45, 2359296
    v_mfma_f32_16x16x32_bf16 v[52:55], a[184:187], v[28:31], v[52:55]
    s_add_u32 s1, s0, 249856
    v_permlane32_swap_b32 v21, v19
    v_mfma_f32_16x16x32_bf16 v[56:59], a[176:179], v[44:47], v[56:59]
    ds_read_b128 v[44:47], v12 offset:29696
    buffer_load_dwordx4 a[240:243], v4, s[8:11], s1 offen offset:0 sc1
    v_mfma_f32_16x16x32_bf16 v[56:59], a[188:191], v[28:31], v[56:59]
    buffer_store_dwordx4 v[16:19], v13, s[8:11], s49 offen sc1
    s_waitcnt lgkmcnt(2)
    v_mfma_f32_16x16x32_bf16 v[48:51], a[192:195], v[32:35], v[48:51]
    v_mfma_f32_16x16x32_bf16 v[48:51], a[204:207], v[36:39], v[48:51]
    v_mfma_f32_16x16x32_bf16 v[52:55], a[196:199], v[32:35], v[52:55]
    s_waitcnt lgkmcnt(0)
    s_waitcnt vmcnt(25)
    s_barrier
    v_mfma_f32_16x16x32_bf16 v[52:55], a[208:211], v[36:39], v[52:55]
    ds_read_b128 v[28:31], v11 offset:10240
    v_mfma_f32_16x16x32_bf16 v[56:59], a[200:203], v[32:35], v[56:59]
    ds_read_b128 v[32:35], v11 offset:11264
    v_mfma_f32_16x16x32_bf16 v[56:59], a[212:215], v[36:39], v[56:59]
    ds_read_b128 v[36:39], v11 offset:12288
    v_mfma_f32_16x16x32_bf16 v[48:51], a[216:219], v[40:43], v[48:51]
    v_mfma_f32_16x16x32_bf16 v[48:51], a[228:231], v[44:47], v[48:51]
    s_add_u32 m0, s36, 5120
    v_add_u32 v0, 2293760, v4
    v_mfma_f32_16x16x32_bf16 v[52:55], a[220:223], v[40:43], v[52:55]
    buffer_load_dwordx4 v0, s[8:11], s29 offen offset:0 sc1 lds
    v_mfma_f32_16x16x32_bf16 v[52:55], a[232:235], v[44:47], v[52:55]
    ds_read_b64 v[24:25], v14 offset:512
    v_mfma_f32_16x16x32_bf16 v[56:59], a[224:227], v[40:43], v[56:59]
    ds_read_b128 v[40:43], v11 offset:13312
    v_mfma_f32_16x16x32_bf16 v[56:59], a[236:239], v[44:47], v[56:59]
    buffer_load_dwordx4 v0, s[8:11], s30 offen offset:1024 sc1 lds
    s_waitcnt lgkmcnt(3)
    v_mfma_f32_16x16x32_bf16 v[60:63], a[0:3], v[28:31], 0
    ds_read_b128 v[44:47], v11 offset:14336
    v_mfma_f32_16x16x32_bf16 v[60:63], a[12:15], v[32:35], v[60:63]
    v_mfma_f32_16x16x32_bf16 v[64:67], a[4:7], v[28:31], 0
    buffer_load_dwordx4 v0, s[8:11], s31 offen offset:2048 sc1 lds
    buffer_load_dwordx4 v0, s[8:11], s37 offen offset:3072 sc1 lds
    s_cmp_lg_u32 s28, 0
    s_cbranch_scc1 L_sk1
    s_lshl4_add_u32 s3, s2, 5029888
    buffer_store_dword v92, off, s[8:11], s3 sc1
L_sk1:
    v_mfma_f32_16x16x32_bf16 v[64:67], a[16:19], v[32:35], v[64:67]
    s_waitcnt lgkmcnt(2)
    v_mul_f32 v48, v48, v24
    v_mfma_f32_16x16x32_bf16 v[68:71], a[8:11], v[28:31], 0
    ds_read_b128 v[28:31], v11 offset:30720
    v_mul_f32 v49, v49, v24
    v_mfma_f32_16x16x32_bf16 v[68:71], a[20:23], v[32:35], v[68:71]
    ds_read_b128 v[32:35], v11 offset:31744
    s_waitcnt lgkmcnt(3)
    v_mfma_f32_16x16x32_bf16 v[60:63], a[24:27], v[36:39], v[60:63]
    v_exp_f32 v48, v48
    v_mfma_f32_16x16x32_bf16 v[60:63], a[36:39], v[40:43], v[60:63]
    v_mul_f32 v50, v50, v24
    v_mul_f32 v51, v51, v24
    v_mfma_f32_16x16x32_bf16 v[64:67], a[28:31], v[36:39], v[64:67]
    s_add_u32 m0, s36, 9216
    v_mul_f32 v56, v56, v24
    v_mfma_f32_16x16x32_bf16 v[64:67], a[40:43], v[40:43], v[64:67]
    buffer_load_dwordx4 v0, s[8:11], s48 offen offset:0 sc1 lds
    v_mfma_f32_16x16x32_bf16 v[68:71], a[32:35], v[36:39], v[68:71]
    ds_read_b128 v[36:39], v11 offset:32768
    v_mul_f32 v57, v57, v24
    v_mfma_f32_16x16x32_bf16 v[68:71], a[44:47], v[40:43], v[68:71]
    ds_read_b128 v[40:43], v11 offset:33792
    v_exp_f32 v49, v49
    s_waitcnt lgkmcnt(3)
    v_mfma_f32_16x16x32_bf16 v[60:63], a[48:51], v[44:47], v[60:63]
    s_add_u32 s1, s0, 286720
    v_fma_f32 v48, v48, v25, v25
    v_mfma_f32_16x16x32_bf16 v[60:63], a[60:63], v[28:31], v[60:63]
    buffer_load_dwordx4 a[244:247], v4, s[8:11], s1 offen offset:0 sc1
    v_mfma_f32_16x16x32_bf16 v[64:67], a[52:55], v[44:47], v[64:67]
    v_exp_f32 v50, v50
    v_mfma_f32_16x16x32_bf16 v[64:67], a[64:67], v[28:31], v[64:67]
    v_exp_f32 v51, v51
    v_mfma_f32_16x16x32_bf16 v[68:71], a[56:59], v[44:47], v[68:71]
    ds_read_b128 v[44:47], v11 offset:34816
    v_fma_f32 v49, v49, v25, v25
    v_mfma_f32_16x16x32_bf16 v[68:71], a[68:71], v[28:31], v[68:71]
    ds_read_b128 v[28:31], v12 offset:10240
    buffer_load_dwordx4 a[248:251], v4, s[8:11], s1 offen offset:1024 sc1
    s_waitcnt lgkmcnt(3)
    v_mfma_f32_16x16x32_bf16 v[60:63], a[72:75], v[32:35], v[60:63]
    v_exp_f32 v56, v56
    v_mfma_f32_16x16x32_bf16 v[60:63], a[84:87], v[36:39], v[60:63]
    v_fma_f32 v50, v50, v25, v25
    v_fma_f32 v51, v51, v25, v25
    v_mfma_f32_16x16x32_bf16 v[64:67], a[76:79], v[32:35], v[64:67]
    v_exp_f32 v57, v57
    v_mfma_f32_16x16x32_bf16 v[64:67], a[88:91], v[36:39], v[64:67]
    buffer_load_dwordx4 a[252:255], v4, s[8:11], s1 offen offset:2048 sc1
    v_mfma_f32_16x16x32_bf16 v[68:71], a[80:83], v[32:35], v[68:71]
    ds_read_b128 v[32:35], v12 offset:11264
    v_fma_f32 v56, v56, v25, v25
    v_mfma_f32_16x16x32_bf16 v[68:71], a[92:95], v[36:39], v[68:71]
    ds_read_b128 v[36:39], v12 offset:12288
    v_rcp_f32 v48, v48
    s_waitcnt lgkmcnt(3)
    v_mfma_f32_16x16x32_bf16 v[60:63], a[96:99], v[40:43], v[60:63]
    v_rcp_f32 v49, v49
    v_mfma_f32_16x16x32_bf16 v[60:63], a[108:111], v[44:47], v[60:63]
    s_add_u32 m0, s36, 12288
    v_fma_f32 v57, v57, v25, v25
    v_mfma_f32_16x16x32_bf16 v[64:67], a[100:103], v[40:43], v[64:67]
    buffer_load_dwordx4 v4, s[8:11], s1 offen offset:3072 sc1 lds
    v_mfma_f32_16x16x32_bf16 v[64:67], a[112:115], v[44:47], v[64:67]
    v_rcp_f32 v50, v50
    v_mfma_f32_16x16x32_bf16 v[68:71], a[104:107], v[40:43], v[68:71]
    ds_read_b128 v[40:43], v12 offset:13312
    v_mul_f32 v48, v48, v52
    v_mfma_f32_16x16x32_bf16 v[68:71], a[116:119], v[44:47], v[68:71]
    ds_read_b128 v[44:47], v12 offset:14336
    s_add_u32 m0, s36, 16384
    s_waitcnt lgkmcnt(3)
    v_mfma_f32_16x16x32_bf16 v[60:63], a[120:123], v[28:31], v[60:63]
    buffer_load_dword v27, v6, s[8:11], s43 offen offset:0 sc1
    s_add_u32 s1, s0, 290816
    v_mfma_f32_16x16x32_bf16 v[60:63], a[132:135], v[32:35], v[60:63]
    buffer_load_dwordx4 v4, s[8:11], s1 offen offset:0 sc1 lds
    v_rcp_f32 v51, v51
    v_mfma_f32_16x16x32_bf16 v[64:67], a[124:127], v[28:31], v[64:67]
    v_mul_f32 v49, v49, v53
    v_mul_f32 v50, v50, v54
    v_rcp_f32 v56, v56
    v_mfma_f32_16x16x32_bf16 v[64:67], a[136:139], v[32:35], v[64:67]
    v_rcp_f32 v57, v57
    v_mfma_f32_16x16x32_bf16 v[68:71], a[128:131], v[28:31], v[68:71]
    ds_read_b128 v[28:31], v12 offset:30720
    s_add_u32 m0, s35, 0
    s_add_u32 s1, s0, 327680
    v_mfma_f32_16x16x32_bf16 v[68:71], a[140:143], v[32:35], v[68:71]
    ds_read_b128 v[32:35], v12 offset:31744
    buffer_load_dwordx4 v4, s[8:11], s1 offen offset:0 sc1 lds
    s_waitcnt lgkmcnt(3)
    v_mfma_f32_16x16x32_bf16 v[60:63], a[144:147], v[36:39], v[60:63]
    v_mul_f32 v51, v51, v55
    v_cvt_pk_bf16_f32 v20, v48, v49
    v_mfma_f32_16x16x32_bf16 v[60:63], a[156:159], v[40:43], v[60:63]
    v_mul_f32 v56, v56, v58
    v_cvt_pk_bf16_f32 v21, v50, v51
    v_mfma_f32_16x16x32_bf16 v[64:67], a[148:151], v[36:39], v[64:67]
    v_mul_f32 v57, v57, v59
    v_cvt_pk_bf16_f32 v16, v48, v49
    v_mfma_f32_16x16x32_bf16 v[64:67], a[160:163], v[40:43], v[64:67]
    buffer_load_dwordx4 v4, s[8:11], s1 offen offset:1024 sc1 lds
    v_mfma_f32_16x16x32_bf16 v[68:71], a[152:155], v[36:39], v[68:71]
    ds_read_b128 v[36:39], v12 offset:32768
    v_cvt_pk_bf16_f32 v22, v56, v57
    v_mfma_f32_16x16x32_bf16 v[68:71], a[164:167], v[40:43], v[68:71]
    ds_read_b128 v[40:43], v12 offset:33792
    v_permlane16_swap_b32 v20, v21
    s_waitcnt lgkmcnt(3)
    v_mfma_f32_16x16x32_bf16 v[60:63], a[168:171], v[44:47], v[60:63]
    v_cvt_pk_bf16_f32 v17, v50, v51
    v_cvt_pk_bf16_f32 v18, v56, v57
    v_mfma_f32_16x16x32_bf16 v[60:63], a[180:183], v[28:31], v[60:63]
    buffer_load_dwordx4 v4, s[8:11], s1 offen offset:2048 sc1 lds
    v_permlane16_swap_b32 v22, v19
    v_mfma_f32_16x16x32_bf16 v[64:67], a[172:175], v[44:47], v[64:67]
    s_add_u32 s49, s45, 3145728
    v_mfma_f32_16x16x32_bf16 v[64:67], a[184:187], v[28:31], v[64:67]
    v_permlane32_swap_b32 v21, v19
    v_mfma_f32_16x16x32_bf16 v[68:71], a[176:179], v[44:47], v[68:71]
    ds_read_b128 v[44:47], v12 offset:34816
    v_mfma_f32_16x16x32_bf16 v[68:71], a[188:191], v[28:31], v[68:71]
    buffer_store_dwordx4 v[16:19], v13, s[8:11], s49 offen sc1
    s_waitcnt lgkmcnt(2)
    v_mfma_f32_16x16x32_bf16 v[60:63], a[192:195], v[32:35], v[60:63]
    v_mfma_f32_16x16x32_bf16 v[60:63], a[204:207], v[36:39], v[60:63]
    v_mfma_f32_16x16x32_bf16 v[64:67], a[196:199], v[32:35], v[64:67]
    s_waitcnt lgkmcnt(0)
    s_waitcnt vmcnt(15)
    s_barrier
    v_mfma_f32_16x16x32_bf16 v[64:67], a[208:211], v[36:39], v[64:67]
    ds_read_b128 v[28:31], v11 offset:0
    v_mfma_f32_16x16x32_bf16 v[68:71], a[200:203], v[32:35], v[68:71]
    ds_read_b128 v[32:35], v11 offset:1024
    v_mfma_f32_16x16x32_bf16 v[68:71], a[212:215], v[36:39], v[68:71]
    ds_read_b128 v[36:39], v11 offset:2048
    v_mfma_f32_16x16x32_bf16 v[60:63], a[216:219], v[40:43], v[60:63]
    buffer_store_dword v23, v26, s[8:11], 0 offen offset:128 sc1
    v_mfma_f32_16x16x32_bf16 v[60:63], a[228:231], v[44:47], v[60:63]
    buffer_load_dwordx4 v4, s[8:11], s1 offen offset:3072 sc1 lds
    v_mfma_f32_16x16x32_bf16 v[64:67], a[220:223], v[40:43], v[64:67]
    ds_read_b64 v[24:25], v14 offset:640
    v_mfma_f32_16x16x32_bf16 v[64:67], a[232:235], v[44:47], v[64:67]
    v_mfma_f32_16x16x32_bf16 v[68:71], a[224:227], v[40:43], v[68:71]
    s_add_u32 m0, s35, 4096
    s_add_u32 s1, s0, 331776
    v_mfma_f32_16x16x32_bf16 v[68:71], a[236:239], v[44:47], v[68:71]
    ds_read_b128 v[40:43], v11 offset:3072
    buffer_load_dwordx4 v4, s[8:11], s1 offen offset:0 sc1 lds
    s_waitcnt lgkmcnt(3)
    v_mfma_f32_16x16x32_bf16 v[48:51], a[0:3], v[28:31], 0
    ds_read_b128 v[44:47], v11 offset:4096
    v_mfma_f32_16x16x32_bf16 v[48:51], a[12:15], v[32:35], v[48:51]
    v_mfma_f32_16x16x32_bf16 v[52:55], a[4:7], v[28:31], 0
    s_add_u32 m0, s35, 5120
    s_add_u32 s1, s0, 368640
    v_mfma_f32_16x16x32_bf16 v[52:55], a[16:19], v[32:35], v[52:55]
    buffer_load_dwordx4 v4, s[8:11], s1 offen offset:0 sc1 lds
    v_mfma_f32_16x16x32_bf16 v[56:59], a[8:11], v[28:31], 0
    ds_read_b128 v[28:31], v11 offset:20480
    s_waitcnt lgkmcnt(3)
    v_mfma_f32_16x16x32_bf16 v[56:59], a[20:23], v[32:35], v[56:59]
    ds_read_b128 v[32:35], v11 offset:21504
    s_waitcnt lgkmcnt(3)
    v_mfma_f32_16x16x32_bf16 v[48:51], a[24:27], v[36:39], v[48:51]
    v_mul_f32 v60, v60, v24
    v_mul_f32 v61, v61, v24
    v_mfma_f32_16x16x32_bf16 v[48:51], a[36:39], v[40:43], v[48:51]
    buffer_load_dwordx4 v4, s[8:11], s1 offen offset:1024 sc1 lds
    v_mfma_f32_16x16x32_bf16 v[52:55], a[28:31], v[36:39], v[52:55]
    v_exp_f32 v60, v60
    v_mfma_f32_16x16x32_bf16 v[52:55], a[40:43], v[40:43], v[52:55]
    v_mul_f32 v62, v62, v24
    v_mul_f32 v63, v63, v24
    v_mfma_f32_16x16x32_bf16 v[56:59], a[32:35], v[36:39], v[56:59]
    ds_read_b128 v[36:39], v11 offset:22528
    v_mul_f32 v68, v68, v24
    v_mfma_f32_16x16x32_bf16 v[56:59], a[44:47], v[40:43], v[56:59]
    ds_read_b128 v[40:43], v11 offset:23552
    v_exp_f32 v61, v61
    s_waitcnt lgkmcnt(3)
    v_mfma_f32_16x16x32_bf16 v[48:51], a[48:51], v[44:47], v[48:51]
    buffer_load_dwordx4 v4, s[8:11], s1 offen offset:2048 sc1 lds
    v_mfma_f32_16x16x32_bf16 v[48:51], a[60:63], v[28:31], v[48:51]
    v_mul_f32 v69, v69, v24
    v_fma_f32 v60, v60, v25, v25
    v_mfma_f32_16x16x32_bf16 v[52:55], a[52:55], v[44:47], v[52:55]
    v_exp_f32 v62, v62
    v_mfma_f32_16x16x32_bf16 v[52:55], a[64:67], v[28:31], v[52:55]
    v_exp_f32 v63, v63
    v_mfma_f32_16x16x32_bf16 v[56:59], a[56:59], v[44:47], v[56:59]
    ds_read_b128 v[44:47], v11 offset:24576
    buffer_load_dwordx4 v4, s[8:11], s1 offen offset:3072 sc1 lds
    v_mfma_f32_16x16x32_bf16 v[56:59], a[68:71], v[28:31], v[56:59]
    ds_read_b128 v[28:31], v12 offset:0
    s_waitcnt lgkmcnt(3)
    v_mfma_f32_16x16x32_bf16 v[48:51], a[72:75], v[32:35], v[48:51]
    v_fma_f32 v61, v61, v25, v25
    v_fma_f32 v62, v62, v25, v25
    v_exp_f32 v68, v68
    v_mfma_f32_16x16x32_bf16 v[48:51], a[84:87], v[36:39], v[48:51]
    s_add_u32 m0, s35, 9216
    s_add_u32 s1, s0, 372736
    v_mfma_f32_16x16x32_bf16 v[52:55], a[76:79], v[32:35], v[52:55]
    buffer_load_dwordx4 v4, s[8:11], s1 offen offset:0 sc1 lds
    v_mfma_f32_16x16x32_bf16 v[52:55], a[88:91], v[36:39], v[52:55]
    v_exp_f32 v69, v69
    v_mfma_f32_16x16x32_bf16 v[56:59], a[80:83], v[32:35], v[56:59]
    ds_read_b128 v[32:35], v12 offset:1024
    v_fma_f32 v63, v63, v25, v25
    v_mfma_f32_16x16x32_bf16 v[56:59], a[92:95], v[36:39], v[56:59]
    ds_read_b128 v[36:39], v12 offset:2048
    v_rcp_f32 v60, v60
    s_waitcnt lgkmcnt(3)
    v_mfma_f32_16x16x32_bf16 v[48:51], a[96:99], v[40:43], v[48:51]
    v_fma_f32 v68, v68, v25, v25
    v_fma_f32 v69, v69, v25, v25
    v_mfma_f32_16x16x32_bf16 v[48:51], a[108:111], v[44:47], v[48:51]
    v_rcp_f32 v61, v61
    v_mfma_f32_16x16x32_bf16 v[52:55], a[100:103], v[40:43], v[52:55]
    v_rcp_f32 v62, v62
    v_mfma_f32_16x16x32_bf16 v[52:55], a[112:115], v[44:47], v[52:55]
    v_mul_f32 v60, v60, v64
    v_mul_f32 v61, v61, v65
    v_mfma_f32_16x16x32_bf16 v[56:59], a[104:107], v[40:43], v[56:59]
    ds_read_b128 v[40:43], v12 offset:3072
    v_mul_f32 v62, v62, v66
    v_mfma_f32_16x16x32_bf16 v[56:59], a[116:119], v[44:47], v[56:59]
    ds_read_b128 v[44:47], v12 offset:4096
    s_waitcnt lgkmcnt(3)
    v_mfma_f32_16x16x32_bf16 v[48:51], a[120:123], v[28:31], v[48:51]
    v_rcp_f32 v63, v63
    v_mfma_f32_16x16x32_bf16 v[48:51], a[132:135], v[32:35], v[48:51]
    v_rcp_f32 v68, v68
    s_waitcnt vmcnt(13)
    v_cmp_ne_u32 vcc, s34, v27
    s_cbranch_vccnz RT_pf0
BK_pf0:
    v_mfma_f32_16x16x32_bf16 v[52:55], a[124:127], v[28:31], v[52:55]
    s_add_u32 s53, s52, 0
    buffer_load_dwordx4 v[72:75], v4, s[8:11], s53 offen offset:0 sc1
    v_mfma_f32_16x16x32_bf16 v[52:55], a[136:139], v[32:35], v[52:55]
    v_rcp_f32 v69, v69
    v_mfma_f32_16x16x32_bf16 v[56:59], a[128:131], v[28:31], v[56:59]
    ds_read_b128 v[28:31], v12 offset:20480
    v_mul_f32 v63, v63, v67
    v_mfma_f32_16x16x32_bf16 v[56:59], a[140:143], v[32:35], v[56:59]
    ds_read_b128 v[32:35], v12 offset:21504
    buffer_load_dwordx4 v[76:79], v4, s[8:11], s53 offen offset:1024 sc1
    s_waitcnt lgkmcnt(3)
    v_mfma_f32_16x16x32_bf16 v[48:51], a[144:147], v[36:39], v[48:51]
    v_cvt_pk_bf16_f32 v20, v60, v61
    v_mul_f32 v68, v68, v70
    v_mfma_f32_16x16x32_bf16 v[48:51], a[156:159], v[40:43], v[48:51]
    v_cvt_pk_bf16_f32 v21, v62, v63
    v_mul_f32 v69, v69, v71
    v_mfma_f32_16x16x32_bf16 v[52:55], a[148:151], v[36:39], v[52:55]
    v_cvt_pk_bf16_f32 v16, v60, v61
    v_cvt_pk_bf16_f32 v22, v68, v69
    v_mfma_f32_16x16x32_bf16 v[52:55], a[160:163], v[40:43], v[52:55]
    buffer_load_dwordx4 v[80:83], v4, s[8:11], s53 offen offset:2048 sc1
    v_mfma_f32_16x16x32_bf16 v[56:59], a[152:155], v[36:39], v[56:59]
    ds_read_b128 v[36:39], v12 offset:22528
    v_cvt_pk_bf16_f32 v17, v62, v63
    v_mfma_f32_16x16x32_bf16 v[56:59], a[164:167], v[40:43], v[56:59]
    ds_read_b128 v[40:43], v12 offset:23552
    v_permlane16_swap_b32 v20, v21
    s_waitcnt lgkmcnt(3)
    v_mfma_f32_16x16x32_bf16 v[48:51], a[168:171], v[44:47], v[48:51]
    v_permlane16_swap_b32 v22, v19
    v_mfma_f32_16x16x32_bf16 v[48:51], a[180:183], v[28:31], v[48:51]
    buffer_load_dwordx4 v[84:87], v4, s[8:11], s53 offen offset:3072 sc1
    v_mfma_f32_16x16x32_bf16 v[52:55], a[172:175], v[44:47], v[52:55]
    v_cvt_pk_bf16_f32 v18, v68, v69
    s_add_u32 s49, s45, 3932160
    v_mfma_f32_16x16x32_bf16 v[52:55], a[184:187], v[28:31], v[52:55]
    v_permlane32_swap_b32 v21, v19
    v_mfma_f32_16x16x32_bf16 v[56:59], a[176:179], v[44:47], v[56:59]
    ds_read_b128 v[44:47], v12 offset:24576
    s_add_u32 s53, s52, 4096
    v_mfma_f32_16x16x32_bf16 v[56:59], a[188:191], v[28:31], v[56:59]
    buffer_store_dwordx4 v[16:19], v13, s[8:11], s49 offen sc1
    s_waitcnt lgkmcnt(2)
    v_mfma_f32_16x16x32_bf16 v[48:51], a[192:195], v[32:35], v[48:51]
    v_mfma_f32_16x16x32_bf16 v[48:51], a[204:207], v[36:39], v[48:51]
    v_mfma_f32_16x16x32_bf16 v[52:55], a[196:199], v[32:35], v[52:55]
    s_waitcnt lgkmcnt(0)
    s_barrier
    v_mfma_f32_16x16x32_bf16 v[52:55], a[208:211], v[36:39], v[52:55]
    ds_read_b128 v[28:31], v11 offset:5120
    v_mfma_f32_16x16x32_bf16 v[56:59], a[200:203], v[32:35], v[56:59]
    ds_read_b128 v[32:35], v11 offset:6144
    v_mfma_f32_16x16x32_bf16 v[56:59], a[212:215], v[36:39], v[56:59]
    buffer_load_dwordx4 v[88:91], v4, s[8:11], s53 offen offset:0 sc1
    v_mfma_f32_16x16x32_bf16 v[48:51], a[216:219], v[40:43], v[48:51]
    ds_read_b128 v[36:39], v11 offset:7168
    v_mfma_f32_16x16x32_bf16 v[48:51], a[228:231], v[44:47], v[48:51]
    v_mfma_f32_16x16x32_bf16 v[52:55], a[220:223], v[40:43], v[52:55]
    ds_read_b64 v[24:25], v14 offset:768
    v_mfma_f32_16x16x32_bf16 v[52:55], a[232:235], v[44:47], v[52:55]
    buffer_load_dwordx4 v[92:95], v4, s[8:11], s53 offen offset:1024 sc1
    v_mfma_f32_16x16x32_bf16 v[56:59], a[224:227], v[40:43], v[56:59]
    ds_read_b128 v[40:43], v11 offset:8192
    v_mfma_f32_16x16x32_bf16 v[56:59], a[236:239], v[44:47], v[56:59]
    s_waitcnt lgkmcnt(3)
    v_mfma_f32_16x16x32_bf16 v[60:63], a[0:3], v[28:31], 0
    buffer_load_dwordx4 v[96:99], v4, s[8:11], s53 offen offset:2048 sc1
    v_mfma_f32_16x16x32_bf16 v[60:63], a[12:15], v[32:35], v[60:63]
    ds_read_b128 v[44:47], v11 offset:9216
    v_mfma_f32_16x16x32_bf16 v[64:67], a[4:7], v[28:31], 0
    v_mfma_f32_16x16x32_bf16 v[64:67], a[16:19], v[32:35], v[64:67]
    s_waitcnt lgkmcnt(2)
    v_mul_f32 v48, v48, v24
    v_mfma_f32_16x16x32_bf16 v[68:71], a[8:11], v[28:31], 0
    ds_read_b128 v[28:31], v11 offset:25600
    buffer_load_dwordx4 v[100:103], v4, s[8:11], s53 offen offset:3072 sc1
    v_mfma_f32_16x16x32_bf16 v[68:71], a[20:23], v[32:35], v[68:71]
    ds_read_b128 v[32:35], v11 offset:26624
    s_waitcnt lgkmcnt(3)
    v_mfma_f32_16x16x32_bf16 v[60:63], a[24:27], v[36:39], v[60:63]
    v_mul_f32 v49, v49, v24
    v_mul_f32 v50, v50, v24
    v_mfma_f32_16x16x32_bf16 v[60:63], a[36:39], v[40:43], v[60:63]
    s_add_u32 s53, s52, 8192
    v_mul_f32 v51, v51, v24
    v_mfma_f32_16x16x32_bf16 v[64:67], a[28:31], v[36:39], v[64:67]
    buffer_load_dwordx4 v[104:107], v4, s[8:11], s53 offen offset:0 sc1
    v_exp_f32 v48, v48
    v_mfma_f32_16x16x32_bf16 v[64:67], a[40:43], v[40:43], v[64:67]
    v_exp_f32 v49, v49
    v_mfma_f32_16x16x32_bf16 v[68:71], a[32:35], v[36:39], v[68:71]
    ds_read_b128 v[36:39], v11 offset:27648
    v_mul_f32 v56, v56, v24
    v_mfma_f32_16x16x32_bf16 v[68:71], a[44:47], v[40:43], v[68:71]
    ds_read_b128 v[40:43], v11 offset:28672
    s_waitcnt lgkmcnt(3)
    v_mfma_f32_16x16x32_bf16 v[60:63], a[48:51], v[44:47], v[60:63]
    buffer_load_dwordx4 v[108:111], v4, s[8:11], s53 offen offset:1024 sc1
    v_mfma_f32_16x16x32_bf16 v[60:63], a[60:63], v[28:31], v[60:63]
    v_mul_f32 v57, v57, v24
    v_fma_f32 v48, v48, v25, v25
    v_mfma_f32_16x16x32_bf16 v[64:67], a[52:55], v[44:47], v[64:67]
    v_exp_f32 v50, v50
    v_mfma_f32_16x16x32_bf16 v[64:67], a[64:67], v[28:31], v[64:67]
    v_exp_f32 v51, v51
    v_mfma_f32_16x16x32_bf16 v[68:71], a[56:59], v[44:47], v[68:71]
    ds_read_b128 v[44:47], v11 offset:29696
    buffer_load_dwordx4 v[112:115], v4, s[8:11], s53 offen offset:2048 sc1
    v_mfma_f32_16x16x32_bf16 v[68:71], a[68:71], v[28:31], v[68:71]
    ds_read_b128 v[28:31], v12 offset:5120
    s_waitcnt lgkmcnt(3)
    v_mfma_f32_16x16x32_bf16 v[60:63], a[72:75], v[32:35], v[60:63]
    v_fma_f32 v49, v49, v25, v25
    v_fma_f32 v50, v50, v25, v25
    v_exp_f32 v56, v56
    v_mfma_f32_16x16x32_bf16 v[60:63], a[84:87], v[36:39], v[60:63]
    v_exp_f32 v57, v57
    v_mfma_f32_16x16x32_bf16 v[64:67], a[76:79], v[32:35], v[64:67]
    buffer_load_dwordx4 v[116:119], v4, s[8:11], s53 offen offset:3072 sc1
    v_mfma_f32_16x16x32_bf16 v[64:67], a[88:91], v[36:39], v[64:67]
    v_fma_f32 v51, v51, v25, v25
    v_fma_f32 v56, v56, v25, v25
    v_mfma_f32_16x16x32_bf16 v[68:71], a[80:83], v[32:35], v[68:71]
    ds_read_b128 v[32:35], v12 offset:6144
    v_fma_f32 v57, v57, v25, v25
    v_mfma_f32_16x16x32_bf16 v[68:71], a[92:95], v[36:39], v[68:71]
    ds_read_b128 v[36:39], v12 offset:7168
    v_rcp_f32 v48, v48
    s_waitcnt lgkmcnt(3)
    v_mfma_f32_16x16x32_bf16 v[60:63], a[96:99], v[40:43], v[60:63]
    v_rcp_f32 v49, v49
    v_mfma_f32_16x16x32_bf16 v[60:63], a[108:111], v[44:47], v[60:63]
    v_rcp_f32 v50, v50
    v_mfma_f32_16x16x32_bf16 v[64:67], a[100:103], v[40:43], v[64:67]
    v_mul_f32 v48, v48, v52
    v_mul_f32 v49, v49, v53
    v_mfma_f32_16x16x32_bf16 v[64:67], a[112:115], v[44:47], v[64:67]
    v_rcp_f32 v51, v51
    v_mfma_f32_16x16x32_bf16 v[68:71], a[104:107], v[40:43], v[68:71]
    ds_read_b128 v[40:43], v12 offset:8192
    v_mul_f32 v50, v50, v54
    v_mfma_f32_16x16x32_bf16 v[68:71], a[116:119], v[44:47], v[68:71]
    ds_read_b128 v[44:47], v12 offset:9216
    s_waitcnt lgkmcnt(3)
    v_mfma_f32_16x16x32_bf16 v[60:63], a[120:123], v[28:31], v[60:63]
    buffer_load_dword v27, v6, s[8:11], s43 offen offset:128 sc1
    v_mfma_f32_16x16x32_bf16 v[60:63], a[132:135], v[32:35], v[60:63]
    s_add_u32 s1, s0, 409600
    buffer_load_dwordx4 a[96:99], v4, s[8:11], s1 offen offset:0 sc1
    v_mfma_f32_16x16x32_bf16 v[64:67], a[124:127], v[28:31], v[64:67]
    v_rcp_f32 v56, v56
    v_mfma_f32_16x16x32_bf16 v[64:67], a[136:139], v[32:35], v[64:67]
    v_rcp_f32 v57, v57
    v_mfma_f32_16x16x32_bf16 v[68:71], a[128:131], v[28:31], v[68:71]
    ds_read_b128 v[28:31], v12 offset:25600
    buffer_load_dwordx4 a[100:103], v4, s[8:11], s1 offen offset:1024 sc1
    v_mfma_f32_16x16x32_bf16 v[68:71], a[140:143], v[32:35], v[68:71]
    ds_read_b128 v[32:35], v12 offset:26624
    s_waitcnt lgkmcnt(3)
    v_mfma_f32_16x16x32_bf16 v[60:63], a[144:147], v[36:39], v[60:63]
    v_mul_f32 v51, v51, v55
    v_cvt_pk_bf16_f32 v20, v48, v49
    v_mfma_f32_16x16x32_bf16 v[60:63], a[156:159], v[40:43], v[60:63]
    buffer_load_dwordx4 a[104:107], v4, s[8:11], s1 offen offset:2048 sc1
    v_mul_f32 v56, v56, v58
    v_mfma_f32_16x16x32_bf16 v[64:67], a[148:151], v[36:39], v[64:67]
    v_cvt_pk_bf16_f32 v21, v50, v51
    v_mul_f32 v57, v57, v59
    v_mfma_f32_16x16x32_bf16 v[64:67], a[160:163], v[40:43], v[64:67]
    v_cvt_pk_bf16_f32 v16, v48, v49
    v_cvt_pk_bf16_f32 v22, v56, v57
    v_mfma_f32_16x16x32_bf16 v[68:71], a[152:155], v[36:39], v[68:71]
    ds_read_b128 v[36:39], v12 offset:27648
    v_cvt_pk_bf16_f32 v17, v50, v51
    v_mfma_f32_16x16x32_bf16 v[68:71], a[164:167], v[40:43], v[68:71]
    ds_read_b128 v[40:43], v12 offset:28672
    buffer_load_dwordx4 a[108:111], v4, s[8:11], s1 offen offset:3072 sc1
    s_waitcnt lgkmcnt(3)
    v_mfma_f32_16x16x32_bf16 v[60:63], a[168:171], v[44:47], v[60:63]
    v_permlane16_swap_b32 v20, v21
    v_mfma_f32_16x16x32_bf16 v[60:63], a[180:183], v[28:31], v[60:63]
    s_add_u32 s1, s0, 413696
    v_cvt_pk_bf16_f32 v18, v56, v57
    v_permlane16_swap_b32 v22, v19
    v_mfma_f32_16x16x32_bf16 v[64:67], a[172:175], v[44:47], v[64:67]
    buffer_load_dwordx4 a[112:115], v4, s[8:11], s1 offen offset:0 sc1
    v_mfma_f32_16x16x32_bf16 v[64:67], a[184:187], v[28:31], v[64:67]
    s_add_u32 s49, s45, 4718592
    v_permlane32_swap_b32 v21, v19
    v_mfma_f32_16x16x32_bf16 v[68:71], a[176:179], v[44:47], v[68:71]
    ds_read_b128 v[44:47], v12 offset:29696
    v_mfma_f32_16x16x32_bf16 v[68:71], a[188:191], v[28:31], v[68:71]
    buffer_store_dwordx4 v[16:19], v13, s[8:11], s49 offen sc1
    s_waitcnt lgkmcnt(2)
    v_mfma_f32_16x16x32_bf16 v[60:63], a[192:195], v[32:35], v[60:63]
    v_mfma_f32_16x16x32_bf16 v[60:63], a[204:207], v[36:39], v[60:63]
    v_mfma_f32_16x16x32_bf16 v[64:67], a[196:199], v[32:35], v[64:67]
    s_waitcnt lgkmcnt(0)
    s_waitcnt vmcnt(15)
    s_barrier
    v_mfma_f32_16x16x32_bf16 v[64:67], a[208:211], v[36:39], v[64:67]
    ds_read_b128 a[48:51], v5 offset:15360
    ds_read_b128 a[52:55], v5 offset:16384
    v_mfma_f32_16x16x32_bf16 v[68:71], a[200:203], v[32:35], v[68:71]
    ds_read_b128 a[56:59], v15 offset:0
    ds_read_b128 a[60:63], v15 offset:1024
    v_mfma_f32_16x16x32_bf16 v[68:71], a[212:215], v[36:39], v[68:71]
    s_add_u32 s1, s0, 450560
    ds_read_b128 a[64:67], v15 offset:2048
    v_mfma_f32_16x16x32_bf16 v[60:63], a[216:219], v[40:43], v[60:63]
    buffer_store_dword v23, v26, s[8:11], 0 offen offset:256 sc1
    buffer_load_dwordx4 a[116:119], v4, s[8:11], s1 offen offset:0 sc1
    v_mfma_f32_16x16x32_bf16 v[60:63], a[228:231], v[44:47], v[60:63]
    ds_read_b128 a[68:71], v15 offset:3072
    ds_read_b128 a[72:75], v15 offset:4096
    v_mfma_f32_16x16x32_bf16 v[64:67], a[220:223], v[40:43], v[64:67]
    ds_read_b64 v[24:25], v14 offset:896
    v_mfma_f32_16x16x32_bf16 v[64:67], a[232:235], v[44:47], v[64:67]
    v_mfma_f32_16x16x32_bf16 v[68:71], a[224:227], v[40:43], v[68:71]
    buffer_load_dwordx4 a[120:123], v4, s[8:11], s1 offen offset:1024 sc1
    v_mfma_f32_16x16x32_bf16 v[68:71], a[236:239], v[44:47], v[68:71]
    v_mfma_f32_16x16x32_bf16 a[184:187], v[120:123], v[72:75], 0
    v_mfma_f32_16x16x32_bf16 a[184:187], v[140:143], v[76:79], a[184:187]
    buffer_load_dwordx4 a[124:127], v4, s[8:11], s1 offen offset:2048 sc1
    v_mfma_f32_16x16x32_bf16 a[188:191], v[124:127], v[72:75], 0
    v_mfma_f32_16x16x32_bf16 a[188:191], v[144:147], v[76:79], a[188:191]
    s_waitcnt lgkmcnt(0)
    v_mul_f32 v60, v60, v24
    v_mfma_f32_16x16x32_bf16 a[192:195], v[128:131], v[72:75], 0
    v_mul_f32 v61, v61, v24
    v_mul_f32 v62, v62, v24
    v_mfma_f32_16x16x32_bf16 a[192:195], v[148:151], v[76:79], a[192:195]
    buffer_load_dwordx4 a[128:131], v4, s[8:11], s1 offen offset:3072 sc1
    v_mfma_f32_16x16x32_bf16 a[196:199], v[132:135], v[72:75], 0
    v_exp_f32 v60, v60
    v_mfma_f32_16x16x32_bf16 a[196:199], v[152:155], v[76:79], a[196:199]
    s_add_u32 s1, s0, 454656
    v_mul_f32 v63, v63, v24
    v_mfma_f32_16x16x32_bf16 a[200:203], v[136:139], v[72:75], 0
    buffer_load_dwordx4 a[132:135], v4, s[8:11], s1 offen offset:0 sc1
    v_mfma_f32_16x16x32_bf16 a[200:203], v[156:159], v[76:79], a[200:203]
    v_exp_f32 v61, v61
    v_mfma_f32_16x16x32_bf16 a[184:187], v[160:163], v[80:83], a[184:187]
    v_mul_f32 v68, v68, v24
    v_mul_f32 v69, v69, v24
    v_mfma_f32_16x16x32_bf16 a[184:187], v[180:183], v[84:87], a[184:187]
    v_exp_f32 v62, v62
    v_mfma_f32_16x16x32_bf16 a[188:191], v[164:167], v[80:83], a[188:191]
    s_add_u32 s3, s57, 0
    buffer_load_dwordx4 v[28:31], v7, s[8:11], s3 offen sc1
    v_mfma_f32_16x16x32_bf16 a[188:191], v[184:187], v[84:87], a[188:191]
    v_fma_f32 v60, v60, v25, v25
    v_fma_f32 v61, v61, v25, v25
    v_exp_f32 v63, v63
    v_mfma_f32_16x16x32_bf16 a[192:195], v[168:171], v[80:83], a[192:195]
    v_exp_f32 v68, v68
    v_mfma_f32_16x16x32_bf16 a[192:195], v[188:191], v[84:87], a[192:195]
    buffer_load_dwordx4 v[44:47], v10, s[8:11], s58 offen sc1
    v_mfma_f32_16x16x32_bf16 a[196:199], v[172:175], v[80:83], a[196:199]
    v_fma_f32 v62, v62, v25, v25
    v_fma_f32 v63, v63, v25, v25
    s_waitcnt vmcnt(14)
    v_cmp_ne_u32 vcc, s34, v27
    s_cbranch_vccnz RT_pf1
BK_pf1:
    v_mfma_f32_16x16x32_bf16 a[196:199], v[192:195], v[84:87], a[196:199]
    s_add_u32 s53, s52, 1572864
    buffer_load_dwordx4 a[0:3], v4, s[8:11], s53 offen offset:0 sc1
    v_mfma_f32_16x16x32_bf16 a[200:203], v[176:179], v[80:83], a[200:203]
    v_exp_f32 v69, v69
    v_mfma_f32_16x16x32_bf16 a[200:203], v[196:199], v[84:87], a[200:203]
    v_rcp_f32 v60, v60
    v_mfma_f32_16x16x32_bf16 a[184:187], v[200:203], v[88:91], a[184:187]
    buffer_load_dwordx4 a[4:7], v4, s[8:11], s53 offen offset:1024 sc1
    v_fma_f32 v68, v68, v25, v25
    v_mfma_f32_16x16x32_bf16 a[184:187], v[220:223], v[92:95], a[184:187]
    v_rcp_f32 v61, v61
    v_fma_f32 v69, v69, v25, v25
    v_mfma_f32_16x16x32_bf16 a[188:191], v[204:207], v[88:91], a[188:191]
    v_rcp_f32 v62, v62
    v_mfma_f32_16x16x32_bf16 a[188:191], v[224:227], v[92:95], a[188:191]
    ds_read_b128 a[76:79], v15 offset:5120
    v_mul_f32 v60, v60, v64
    v_mfma_f32_16x16x32_bf16 a[192:195], v[208:211], v[88:91], a[192:195]
    buffer_load_dwordx4 a[8:11], v4, s[8:11], s53 offen offset:2048 sc1
    v_rcp_f32 v63, v63
    v_mfma_f32_16x16x32_bf16 a[192:195], v[228:231], v[92:95], a[192:195]
    v_mul_f32 v61, v61, v65
    ds_read_b128 a[80:83], v15 offset:6144
    v_rcp_f32 v68, v68
    v_mfma_f32_16x16x32_bf16 a[196:199], v[212:215], v[88:91], a[196:199]
    v_mul_f32 v62, v62, v66
    v_mul_f32 v63, v63, v67
    v_mfma_f32_16x16x32_bf16 a[196:199], v[232:235], v[92:95], a[196:199]
    v_rcp_f32 v69, v69
    v_mfma_f32_16x16x32_bf16 a[200:203], v[216:219], v[88:91], a[200:203]
    buffer_load_dwordx4 a[12:15], v4, s[8:11], s53 offen offset:3072 sc1
    v_mfma_f32_16x16x32_bf16 a[200:203], v[236:239], v[92:95], a[200:203]
    v_cvt_pk_bf16_f32 v20, v60, v61
    v_mul_f32 v68, v68, v70
    v_mfma_f32_16x16x32_bf16 a[184:187], v[240:243], v[96:99], a[184:187]
    ds_read_b128 a[84:87], v15 offset:7168
    v_cvt_pk_bf16_f32 v21, v62, v63
    v_mfma_f32_16x16x32_bf16 a[184:187], a[244:247], v[100:103], a[184:187]
    s_add_u32 s53, s52, 1576960
    v_mul_f32 v69, v69, v71
    v_cvt_pk_bf16_f32 v16, v60, v61
    v_mfma_f32_16x16x32_bf16 a[188:191], v[244:247], v[96:99], a[188:191]
    buffer_load_dwordx4 a[16:19], v4, s[8:11], s53 offen offset:0 sc1
    v_cvt_pk_bf16_f32 v22, v68, v69
    v_mfma_f32_16x16x32_bf16 a[188:191], a[248:251], v[100:103], a[188:191]
    v_permlane16_swap_b32 v20, v21
    ds_read_b128 a[88:91], v15 offset:8192
    v_mfma_f32_16x16x32_bf16 a[192:195], v[248:251], v[96:99], a[192:195]
    v_cvt_pk_bf16_f32 v17, v62, v63
    v_cvt_pk_bf16_f32 v18, v68, v69
    v_permlane16_swap_b32 v22, v19
    v_mfma_f32_16x16x32_bf16 a[192:195], a[252:255], v[100:103], a[192:195]
    s_add_u32 s49, s45, 5505024
    ds_read_b128 a[92:95], v15 offset:9216
    v_mfma_f32_16x16x32_bf16 a[196:199], v[252:255], v[96:99], a[196:199]
    v_permlane32_swap_b32 v21, v19
    buffer_store_dwordx4 v[16:19], v13, s[8:11], s49 offen sc1
    v_mfma_f32_16x16x32_bf16 a[196:199], a[48:51], v[100:103], a[196:199]
    v_mfma_f32_16x16x32_bf16 a[200:203], a[240:243], v[96:99], a[200:203]
    v_mfma_f32_16x16x32_bf16 a[200:203], a[52:55], v[100:103], a[200:203]
    v_mfma_f32_16x16x32_bf16 a[184:187], a[56:59], v[104:107], a[184:187]
    s_waitcnt lgkmcnt(0)
    v_mfma_f32_16x16x32_bf16 a[184:187], a[76:79], v[108:111], a[184:187]
    v_mfma_f32_16x16x32_bf16 a[188:191], a[60:63], v[104:107], a[188:191]
    buffer_load_dword v27, v6, s[8:11], s43 offen offset:256 sc1
    v_mfma_f32_16x16x32_bf16 a[188:191], a[80:83], v[108:111], a[188:191]
    buffer_load_dwordx4 a[20:23], v4, s[8:11], s53 offen offset:1024 sc1
    v_mfma_f32_16x16x32_bf16 a[192:195], a[64:67], v[104:107], a[192:195]
    v_mul_u32_u24 v11, 336, v2
    v_lshl_add_u32 v11, v3, 4, v11
    v_mfma_f32_16x16x32_bf16 a[192:195], a[84:87], v[108:111], a[192:195]
    v_add_u32 v11, s36, v11
    v_mfma_f32_16x16x32_bf16 a[196:199], a[68:71], v[104:107], a[196:199]
    buffer_load_dwordx4 a[24:27], v4, s[8:11], s53 offen offset:2048 sc1
    v_mfma_f32_16x16x32_bf16 a[196:199], a[88:91], v[108:111], a[196:199]
    v_mfma_f32_16x16x32_bf16 a[200:203], a[72:75], v[104:107], a[200:203]
    v_add_u32 v12, 40960, v9
    v_mfma_f32_16x16x32_bf16 a[200:203], a[92:95], v[108:111], a[200:203]
    s_waitcnt vmcnt(18)
    v_mfma_f32_16x16x32_bf16 a[184:187], a[96:99], v[112:115], a[184:187]
    buffer_load_dwordx4 a[28:31], v4, s[8:11], s53 offen offset:3072 sc1
    s_waitcnt vmcnt(12)
    v_mfma_f32_16x16x32_bf16 a[184:187], a[116:119], v[116:119], a[184:187]
    v_mfma_f32_16x16x32_bf16 a[188:191], a[100:103], v[112:115], a[188:191]
    v_mfma_f32_16x16x32_bf16 a[188:191], a[120:123], v[116:119], a[188:191]
    s_add_u32 s53, s52, 1581056
    v_mfma_f32_16x16x32_bf16 a[192:195], a[104:107], v[112:115], a[192:195]
    buffer_load_dwordx4 a[32:35], v4, s[8:11], s53 offen offset:0 sc1
    v_mfma_f32_16x16x32_bf16 a[192:195], a[124:127], v[116:119], a[192:195]
    v_mfma_f32_16x16x32_bf16 a[196:199], a[108:111], v[112:115], a[196:199]
    v_mfma_f32_16x16x32_bf16 a[196:199], a[128:131], v[116:119], a[196:199]
    v_mfma_f32_16x16x32_bf16 a[200:203], a[112:115], v[112:115], a[200:203]
    buffer_load_dwordx4 a[36:39], v4, s[8:11], s53 offen offset:1024 sc1
    v_mfma_f32_16x16x32_bf16 a[200:203], a[132:135], v[116:119], a[200:203]
    s_waitcnt vmcnt(10)
    v_mfma_f32_16x16x32_bf16 a[204:207], v[120:123], a[0:3], 0
    v_lshlrev_b32 v104, 16, v28
    v_and_b32 v105, 0xffff0000, v28
    v_mfma_f32_16x16x32_bf16 a[204:207], v[140:143], a[4:7], a[204:207]
    v_lshlrev_b32 v106, 16, v29
    v_and_b32 v107, 0xffff0000, v29
    v_mfma_f32_16x16x32_bf16 a[208:211], v[124:127], a[0:3], 0
    buffer_load_dwordx4 a[40:43], v4, s[8:11], s53 offen offset:2048 sc1
    v_mfma_f32_16x16x32_bf16 a[208:211], v[144:147], a[4:7], a[208:211]
    v_lshlrev_b32 v108, 16, v30
    v_and_b32 v109, 0xffff0000, v30
    v_mfma_f32_16x16x32_bf16 a[212:215], v[128:131], a[0:3], 0
    ds_write_b128 v11, a[184:187] offset:0
    v_mfma_f32_16x16x32_bf16 a[212:215], v[148:151], a[4:7], a[212:215]
    buffer_load_dwordx4 a[44:47], v4, s[8:11], s53 offen offset:3072 sc1
    v_mfma_f32_16x16x32_bf16 a[216:219], v[132:135], a[0:3], 0
    v_lshlrev_b32 v110, 16, v31
    v_and_b32 v111, 0xffff0000, v31
    v_mfma_f32_16x16x32_bf16 a[216:219], v[152:155], a[4:7], a[216:219]
    ds_write_b128 v11, a[188:191] offset:64
    v_mfma_f32_16x16x32_bf16 a[220:223], v[136:139], a[0:3], 0
    v_add_f32 v104, v104, v44
    v_mfma_f32_16x16x32_bf16 a[220:223], v[156:159], a[4:7], a[220:223]
    v_add_f32 v105, v105, v44
    s_waitcnt vmcnt(10)
    v_mfma_f32_16x16x32_bf16 a[204:207], v[160:163], a[8:11], a[204:207]
    ds_write_b128 v11, a[192:195] offset:128
    v_mfma_f32_16x16x32_bf16 a[204:207], v[180:183], a[12:15], a[204:207]
    v_add_f32 v106, v106, v44
    v_mfma_f32_16x16x32_bf16 a[208:211], v[164:167], a[8:11], a[208:211]
    s_add_u32 s3, s57, 655360
    buffer_load_dwordx4 v[36:39], v7, s[8:11], s3 offen sc1
    v_mfma_f32_16x16x32_bf16 a[208:211], v[184:187], a[12:15], a[208:211]
    v_add_f32 v107, v107, v44
    ds_write_b128 v11, a[196:199] offset:192
    v_mfma_f32_16x16x32_bf16 a[212:215], v[168:171], a[8:11], a[212:215]
    v_add_f32 v108, v108, v44
    v_mfma_f32_16x16x32_bf16 a[212:215], v[188:191], a[12:15], a[212:215]
    ds_write_b128 v11, a[200:203] offset:256
    v_mfma_f32_16x16x32_bf16 a[216:219], v[172:175], a[8:11], a[216:219]
    v_add_f32 v109, v109, v44
    v_mfma_f32_16x16x32_bf16 a[216:219], v[192:195], a[12:15], a[216:219]
    v_add_f32 v110, v110, v44
    v_mfma_f32_16x16x32_bf16 a[220:223], v[176:179], a[8:11], a[220:223]
    v_mfma_f32_16x16x32_bf16 a[220:223], v[196:199], a[12:15], a[220:223]
    v_add_f32 v111, v111, v44
    s_waitcnt vmcnt(7)
    v_mfma_f32_16x16x32_bf16 a[204:207], v[200:203], a[16:19], a[204:207]
    v_cmp_ne_u32 vcc, s34, v27
    s_cbranch_vccnz RT_pf2
BK_pf2:
    v_mfma_f32_16x16x32_bf16 a[204:207], v[220:223], a[20:23], a[204:207]
    s_add_u32 s53, s52, 3145728
    buffer_load_dwordx4 a[136:139], v4, s[8:11], s53 offen offset:0 sc1
    v_mfma_f32_16x16x32_bf16 a[208:211], v[204:207], a[16:19], a[208:211]
    s_waitcnt lgkmcnt(0)
    s_barrier
    v_mfma_f32_16x16x32_bf16 a[208:211], v[224:227], a[20:23], a[208:211]
    ds_read_b128 v[72:75], v9 offset:0
    ds_read_b128 v[76:79], v9 offset:16
    v_mfma_f32_16x16x32_bf16 a[212:215], v[208:211], a[16:19], a[212:215]
    buffer_load_dwordx4 a[140:143], v4, s[8:11], s53 offen offset:1024 sc1
    v_mfma_f32_16x16x32_bf16 a[212:215], v[228:231], a[20:23], a[212:215]
    ds_read_b128 v[80:83], v9 offset:20480
    ds_read_b128 v[84:87], v9 offset:20496
    v_mfma_f32_16x16x32_bf16 a[216:219], v[212:215], a[16:19], a[216:219]
    ds_read_b128 v[88:91], v12 offset:0
    ds_read_b128 v[92:95], v12 offset:16
    v_mfma_f32_16x16x32_bf16 a[216:219], v[232:235], a[20:23], a[216:219]
    ds_read_b128 v[96:99], v12 offset:20480
    ds_read_b128 v[100:103], v12 offset:20496
    v_mfma_f32_16x16x32_bf16 a[220:223], v[216:219], a[16:19], a[220:223]
    buffer_load_dwordx4 a[144:147], v4, s[8:11], s53 offen offset:2048 sc1
    v_mfma_f32_16x16x32_bf16 a[220:223], v[236:239], a[20:23], a[220:223]
    s_waitcnt vmcnt(8)
    v_mfma_f32_16x16x32_bf16 a[204:207], v[240:243], a[24:27], a[204:207]
    s_waitcnt lgkmcnt(6)
    v_add_f32 v104, v104, v72
    v_mfma_f32_16x16x32_bf16 a[204:207], a[244:247], a[28:31], a[204:207]
    v_add_f32 v105, v105, v73
    v_add_f32 v106, v106, v74
    v_mfma_f32_16x16x32_bf16 a[208:211], v[244:247], a[24:27], a[208:211]
    buffer_load_dwordx4 a[148:151], v4, s[8:11], s53 offen offset:3072 sc1
    v_mfma_f32_16x16x32_bf16 a[208:211], a[248:251], a[28:31], a[208:211]
    v_add_f32 v107, v107, v75
    v_add_f32 v108, v108, v76
    v_mfma_f32_16x16x32_bf16 a[212:215], v[248:251], a[24:27], a[212:215]
    v_add_f32 v109, v109, v77
    v_add_f32 v110, v110, v78
    v_mfma_f32_16x16x32_bf16 a[212:215], a[252:255], a[28:31], a[212:215]
    s_add_u32 s53, s52, 3149824
    v_add_f32 v111, v111, v79
    v_mfma_f32_16x16x32_bf16 a[216:219], v[252:255], a[24:27], a[216:219]
    buffer_load_dwordx4 a[152:155], v4, s[8:11], s53 offen offset:0 sc1
    v_mfma_f32_16x16x32_bf16 a[216:219], a[48:51], a[28:31], a[216:219]
    s_waitcnt lgkmcnt(4)
    v_add_f32 v104, v104, v80
    v_mfma_f32_16x16x32_bf16 a[220:223], a[240:243], a[24:27], a[220:223]
    v_add_f32 v105, v105, v81
    v_add_f32 v106, v106, v82
    v_mfma_f32_16x16x32_bf16 a[220:223], a[52:55], a[28:31], a[220:223]
    v_add_f32 v107, v107, v83
    s_waitcnt vmcnt(8)
    v_mfma_f32_16x16x32_bf16 a[204:207], a[56:59], a[32:35], a[204:207]
    buffer_load_dwordx4 a[156:159], v4, s[8:11], s53 offen offset:1024 sc1
    v_mfma_f32_16x16x32_bf16 a[204:207], a[76:79], a[36:39], a[204:207]
    v_add_f32 v108, v108, v84
    v_add_f32 v109, v109, v85
    v_mfma_f32_16x16x32_bf16 a[208:211], a[60:63], a[32:35], a[208:211]
    v_add_f32 v110, v110, v86
    v_add_f32 v111, v111, v87
    v_mfma_f32_16x16x32_bf16 a[208:211], a[80:83], a[36:39], a[208:211]
    buffer_load_dwordx4 a[160:163], v4, s[8:11], s53 offen offset:2048 sc1
    v_mfma_f32_16x16x32_bf16 a[212:215], a[64:67], a[32:35], a[212:215]
    s_waitcnt lgkmcnt(2)
    v_add_f32 v104, v104, v88
    v_mfma_f32_16x16x32_bf16 a[212:215], a[84:87], a[36:39], a[212:215]
    v_add_f32 v105, v105, v89
    v_add_f32 v106, v106, v90
    v_mfma_f32_16x16x32_bf16 a[216:219], a[68:71], a[32:35], a[216:219]
    v_add_f32 v107, v107, v91
    v_add_f32 v108, v108, v92
    v_mfma_f32_16x16x32_bf16 a[216:219], a[88:91], a[36:39], a[216:219]
    buffer_load_dwordx4 a[164:167], v4, s[8:11], s53 offen offset:3072 sc1
    v_mfma_f32_16x16x32_bf16 a[220:223], a[72:75], a[32:35], a[220:223]
    v_add_f32 v109, v109, v93
    v_add_f32 v110, v110, v94
    v_mfma_f32_16x16x32_bf16 a[220:223], a[92:95], a[36:39], a[220:223]
    v_add_f32 v111, v111, v95
    s_waitcnt vmcnt(9)
    v_mfma_f32_16x16x32_bf16 a[204:207], a[96:99], a[40:43], a[204:207]
    s_add_u32 s53, s52, 3153920
    s_waitcnt lgkmcnt(0)
    v_mfma_f32_16x16x32_bf16 a[204:207], a[116:119], a[44:47], a[204:207]
    buffer_load_dwordx4 a[168:171], v4, s[8:11], s53 offen offset:0 sc1
    v_add_f32 v104, v104, v96
    v_mfma_f32_16x16x32_bf16 a[208:211], a[100:103], a[40:43], a[208:211]
    v_add_f32 v105, v105, v97
    v_add_f32 v106, v106, v98
    v_mfma_f32_16x16x32_bf16 a[208:211], a[120:123], a[44:47], a[208:211]
    v_add_f32 v107, v107, v99
    v_add_f32 v108, v108, v100
    v_mfma_f32_16x16x32_bf16 a[212:215], a[104:107], a[40:43], a[212:215]
    v_add_f32 v109, v109, v101
    v_add_f32 v110, v110, v102
    v_mfma_f32_16x16x32_bf16 a[212:215], a[124:127], a[44:47], a[212:215]
    buffer_load_dwordx4 a[172:175], v4, s[8:11], s53 offen offset:1024 sc1
    v_add_f32 v111, v111, v103
    v_mfma_f32_16x16x32_bf16 a[216:219], a[108:111], a[40:43], a[216:219]
    v_cvt_pk_bf16_f32 v112, v104, v105
    v_cvt_pk_bf16_f32 v113, v106, v107
    v_mfma_f32_16x16x32_bf16 a[216:219], a[128:131], a[44:47], a[216:219]
    v_cvt_pk_bf16_f32 v114, v108, v109
    v_cvt_pk_bf16_f32 v115, v110, v111
    v_mfma_f32_16x16x32_bf16 a[220:223], a[112:115], a[40:43], a[220:223]
    s_add_u32 s3, s59, 0
    buffer_store_dwordx4 v[112:115], v8, s[20:23], s3 offen nt
    v_mfma_f32_16x16x32_bf16 a[220:223], a[132:135], a[44:47], a[220:223]
    s_waitcnt vmcnt(11)
    s_waitcnt vmcnt(9)
    v_mfma_f32_16x16x32_bf16 a[184:187], v[120:123], a[136:139], 0
    v_lshlrev_b32 v104, 16, v36
    v_and_b32 v105, 0xffff0000, v36
    v_mfma_f32_16x16x32_bf16 a[184:187], v[140:143], a[140:143], a[184:187]
    v_lshlrev_b32 v106, 16, v37
    v_and_b32 v107, 0xffff0000, v37
    v_mfma_f32_16x16x32_bf16 a[188:191], v[124:127], a[136:139], 0
    buffer_load_dwordx4 a[176:179], v4, s[8:11], s53 offen offset:2048 sc1
    v_mfma_f32_16x16x32_bf16 a[188:191], v[144:147], a[140:143], a[188:191]
    v_lshlrev_b32 v108, 16, v38
    v_and_b32 v109, 0xffff0000, v38
    v_mfma_f32_16x16x32_bf16 a[192:195], v[128:131], a[136:139], 0
    v_lshlrev_b32 v110, 16, v39
    ds_write_b128 v11, a[204:207] offset:5376
    v_mfma_f32_16x16x32_bf16 a[192:195], v[148:151], a[140:143], a[192:195]
    v_and_b32 v111, 0xffff0000, v39
    v_mfma_f32_16x16x32_bf16 a[196:199], v[132:135], a[136:139], 0
    buffer_load_dwordx4 a[180:183], v4, s[8:11], s53 offen offset:3072 sc1
    v_mfma_f32_16x16x32_bf16 a[196:199], v[152:155], a[140:143], a[196:199]
    v_add_f32 v104, v104, v45
    ds_write_b128 v11, a[208:211] offset:5440
    v_mfma_f32_16x16x32_bf16 a[200:203], v[136:139], a[136:139], 0
    v_mfma_f32_16x16x32_bf16 a[200:203], v[156:159], a[140:143], a[200:203]
    v_add_f32 v105, v105, v45
    s_waitcnt vmcnt(9)
    v_mfma_f32_16x16x32_bf16 a[184:187], v[160:163], a[144:147], a[184:187]
    s_add_u32 s53, s52, 4718592
    buffer_load_dwordx4 a[0:3], v4, s[8:11], s53 offen offset:0 sc1
    v_mfma_f32_16x16x32_bf16 a[184:187], v[180:183], a[148:151], a[184:187]
    v_add_f32 v106, v106, v45
    ds_write_b128 v11, a[212:215] offset:5504
    v_mfma_f32_16x16x32_bf16 a[188:191], v[164:167], a[144:147], a[188:191]
    s_add_u32 s3, s57, 1310720
    v_add_f32 v107, v107, v45
    v_mfma_f32_16x16x32_bf16 a[188:191], v[184:187], a[148:151], a[188:191]
    buffer_load_dwordx4 v[28:31], v7, s[8:11], s3 offen sc1
    ds_write_b128 v11, a[216:219] offset:5568
    v_mfma_f32_16x16x32_bf16 a[192:195], v[168:171], a[144:147], a[192:195]
    v_add_f32 v108, v108, v45
    v_mfma_f32_16x16x32_bf16 a[192:195], v[188:191], a[148:151], a[192:195]
    v_add_f32 v109, v109, v45
    ds_write_b128 v11, a[220:223] offset:5632
    v_mfma_f32_16x16x32_bf16 a[196:199], v[172:175], a[144:147], a[196:199]
    v_mfma_f32_16x16x32_bf16 a[196:199], v[192:195], a[148:151], a[196:199]
    buffer_load_dwordx4 a[4:7], v4, s[8:11], s53 offen offset:1024 sc1
    v_mfma_f32_16x16x32_bf16 a[200:203], v[176:179], a[144:147], a[200:203]
    v_add_f32 v110, v110, v45
    v_mfma_f32_16x16x32_bf16 a[200:203], v[196:199], a[148:151], a[200:203]
    v_add_f32 v111, v111, v45
    s_waitcnt vmcnt(10)
    v_mfma_f32_16x16x32_bf16 a[184:187], v[200:203], a[152:155], a[184:187]
    v_mfma_f32_16x16x32_bf16 a[184:187], v[220:223], a[156:159], a[184:187]
    buffer_load_dwordx4 a[8:11], v4, s[8:11], s53 offen offset:2048 sc1
    v_mfma_f32_16x16x32_bf16 a[188:191], v[204:207], a[152:155], a[188:191]
    s_waitcnt lgkmcnt(0)
    s_barrier
    v_mfma_f32_16x16x32_bf16 a[188:191], v[224:227], a[156:159], a[188:191]
    ds_read_b128 v[72:75], v9 offset:5376
    ds_read_b128 v[76:79], v9 offset:5392
    v_mfma_f32_16x16x32_bf16 a[192:195], v[208:211], a[152:155], a[192:195]
    buffer_load_dwordx4 a[12:15], v4, s[8:11], s53 offen offset:3072 sc1
    v_mfma_f32_16x16x32_bf16 a[192:195], v[228:231], a[156:159], a[192:195]
    ds_read_b128 v[80:83], v9 offset:25856
    ds_read_b128 v[84:87], v9 offset:25872
    v_mfma_f32_16x16x32_bf16 a[196:199], v[212:215], a[152:155], a[196:199]
    ds_read_b128 v[88:91], v12 offset:5376
    ds_read_b128 v[92:95], v12 offset:5392
    v_mfma_f32_16x16x32_bf16 a[196:199], v[232:235], a[156:159], a[196:199]
    s_add_u32 s53, s52, 4722688
    ds_read_b128 v[96:99], v12 offset:25856
    v_mfma_f32_16x16x32_bf16 a[200:203], v[216:219], a[152:155], a[200:203]
    ds_read_b128 v[100:103], v12 offset:25872
    buffer_load_dwordx4 a[16:19], v4, s[8:11], s53 offen offset:0 sc1
    v_mfma_f32_16x16x32_bf16 a[200:203], v[236:239], a[156:159], a[200:203]
    s_waitcnt vmcnt(11)
    v_mfma_f32_16x16x32_bf16 a[184:187], v[240:243], a[160:163], a[184:187]
    s_waitcnt lgkmcnt(6)
    v_add_f32 v104, v104, v72
    v_mfma_f32_16x16x32_bf16 a[184:187], a[244:247], a[164:167], a[184:187]
    v_add_f32 v105, v105, v73
    v_add_f32 v106, v106, v74
    v_mfma_f32_16x16x32_bf16 a[188:191], v[244:247], a[160:163], a[188:191]
    buffer_load_dwordx4 a[20:23], v4, s[8:11], s53 offen offset:1024 sc1
    v_mfma_f32_16x16x32_bf16 a[188:191], a[248:251], a[164:167], a[188:191]
    v_add_f32 v107, v107, v75
    v_add_f32 v108, v108, v76
    v_mfma_f32_16x16x32_bf16 a[192:195], v[248:251], a[160:163], a[192:195]
    v_add_f32 v109, v109, v77
    v_add_f32 v110, v110, v78
    v_mfma_f32_16x16x32_bf16 a[192:195], a[252:255], a[164:167], a[192:195]
    v_add_f32 v111, v111, v79
    s_waitcnt lgkmcnt(4)
    v_mfma_f32_16x16x32_bf16 a[196:199], v[252:255], a[160:163], a[196:199]
    buffer_load_dwordx4 a[24:27], v4, s[8:11], s53 offen offset:2048 sc1
    v_mfma_f32_16x16x32_bf16 a[196:199], a[48:51], a[164:167], a[196:199]
    v_add_f32 v104, v104, v80
    v_add_f32 v105, v105, v81
    v_mfma_f32_16x16x32_bf16 a[200:203], a[240:243], a[160:163], a[200:203]
    v_add_f32 v106, v106, v82
    v_add_f32 v107, v107, v83
    v_mfma_f32_16x16x32_bf16 a[200:203], a[52:55], a[164:167], a[200:203]
    v_add_f32 v108, v108, v84
    s_waitcnt vmcnt(11)
    v_mfma_f32_16x16x32_bf16 a[184:187], a[56:59], a[168:171], a[184:187]
    s_add_u32 s3, s57, 1966080
    buffer_load_dwordx4 v[36:39], v7, s[8:11], s3 offen sc1
    v_mfma_f32_16x16x32_bf16 a[184:187], a[76:79], a[172:175], a[184:187]
    v_add_f32 v109, v109, v85
    v_add_f32 v110, v110, v86
    v_mfma_f32_16x16x32_bf16 a[188:191], a[60:63], a[168:171], a[188:191]
    v_add_f32 v111, v111, v87
    s_waitcnt lgkmcnt(2)
    v_mfma_f32_16x16x32_bf16 a[188:191], a[80:83], a[172:175], a[188:191]
    buffer_load_dwordx4 a[28:31], v4, s[8:11], s53 offen offset:3072 sc1
    v_mfma_f32_16x16x32_bf16 a[192:195], a[64:67], a[168:171], a[192:195]
    v_add_f32 v104, v104, v88
    v_add_f32 v105, v105, v89
    v_mfma_f32_16x16x32_bf16 a[192:195], a[84:87], a[172:175], a[192:195]
    v_add_f32 v106, v106, v90
    v_add_f32 v107, v107, v91
    v_mfma_f32_16x16x32_bf16 a[196:199], a[68:71], a[168:171], a[196:199]
    s_add_u32 s53, s52, 4726784
    v_add_f32 v108, v108, v92
    v_mfma_f32_16x16x32_bf16 a[196:199], a[88:91], a[172:175], a[196:199]
    buffer_load_dwordx4 a[32:35], v4, s[8:11], s53 offen offset:0 sc1
    v_mfma_f32_16x16x32_bf16 a[200:203], a[72:75], a[168:171], a[200:203]
    v_add_f32 v109, v109, v93
    v_add_f32 v110, v110, v94
    v_mfma_f32_16x16x32_bf16 a[200:203], a[92:95], a[172:175], a[200:203]
    v_add_f32 v111, v111, v95
    s_waitcnt vmcnt(11)
    v_mfma_f32_16x16x32_bf16 a[184:187], a[96:99], a[176:179], a[184:187]
    s_waitcnt lgkmcnt(0)
    v_add_f32 v104, v104, v96
    v_mfma_f32_16x16x32_bf16 a[184:187], a[116:119], a[180:183], a[184:187]
    buffer_load_dwordx4 a[36:39], v4, s[8:11], s53 offen offset:1024 sc1
    v_add_f32 v105, v105, v97
    v_mfma_f32_16x16x32_bf16 a[188:191], a[100:103], a[176:179], a[188:191]
    v_add_f32 v106, v106, v98
    v_add_f32 v107, v107, v99
    v_mfma_f32_16x16x32_bf16 a[188:191], a[120:123], a[180:183], a[188:191]
    v_add_f32 v108, v108, v100
    v_add_f32 v109, v109, v101
    v_mfma_f32_16x16x32_bf16 a[192:195], a[104:107], a[176:179], a[192:195]
    buffer_load_dwordx4 a[40:43], v4, s[8:11], s53 offen offset:2048 sc1
    v_mfma_f32_16x16x32_bf16 a[192:195], a[124:127], a[180:183], a[192:195]
    v_add_f32 v110, v110, v102
    v_add_f32 v111, v111, v103
    v_mfma_f32_16x16x32_bf16 a[196:199], a[108:111], a[176:179], a[196:199]
    v_cvt_pk_bf16_f32 v112, v104, v105
    v_cvt_pk_bf16_f32 v113, v106, v107
    v_mfma_f32_16x16x32_bf16 a[196:199], a[128:131], a[180:183], a[196:199]
    v_cvt_pk_bf16_f32 v114, v108, v109
    v_cvt_pk_bf16_f32 v115, v110, v111
    v_mfma_f32_16x16x32_bf16 a[200:203], a[112:115], a[176:179], a[200:203]
    s_add_u32 s3, s59, 655360
    buffer_store_dwordx4 v[112:115], v8, s[20:23], s3 offen nt
    v_mfma_f32_16x16x32_bf16 a[200:203], a[132:135], a[180:183], a[200:203]
    s_waitcnt vmcnt(12)
    s_waitcnt vmcnt(11)
    v_mfma_f32_16x16x32_bf16 a[204:207], v[120:123], a[0:3], 0
    v_lshlrev_b32 v104, 16, v28
    v_and_b32 v105, 0xffff0000, v28
    v_mfma_f32_16x16x32_bf16 a[204:207], v[140:143], a[4:7], a[204:207]
    v_lshlrev_b32 v106, 16, v29
    v_and_b32 v107, 0xffff0000, v29
    v_mfma_f32_16x16x32_bf16 a[208:211], v[124:127], a[0:3], 0
    buffer_load_dwordx4 a[44:47], v4, s[8:11], s53 offen offset:3072 sc1
    v_mfma_f32_16x16x32_bf16 a[208:211], v[144:147], a[4:7], a[208:211]
    v_lshlrev_b32 v108, 16, v30
    v_and_b32 v109, 0xffff0000, v30
    v_mfma_f32_16x16x32_bf16 a[212:215], v[128:131], a[0:3], 0
    v_lshlrev_b32 v110, 16, v31
    ds_write_b128 v11, a[184:187] offset:0
    v_mfma_f32_16x16x32_bf16 a[212:215], v[148:151], a[4:7], a[212:215]
    v_and_b32 v111, 0xffff0000, v31
    v_mfma_f32_16x16x32_bf16 a[216:219], v[132:135], a[0:3], 0
    ds_write_b128 v11, a[188:191] offset:64
    v_mfma_f32_16x16x32_bf16 a[216:219], v[152:155], a[4:7], a[216:219]
    v_add_f32 v104, v104, v46
    v_mfma_f32_16x16x32_bf16 a[220:223], v[136:139], a[0:3], 0
    v_mfma_f32_16x16x32_bf16 a[220:223], v[156:159], a[4:7], a[220:223]
    v_add_f32 v105, v105, v46
    s_waitcnt vmcnt(10)
    v_mfma_f32_16x16x32_bf16 a[204:207], v[160:163], a[8:11], a[204:207]
    v_add_f32 v106, v106, v46
    ds_write_b128 v11, a[192:195] offset:128
    v_mfma_f32_16x16x32_bf16 a[204:207], v[180:183], a[12:15], a[204:207]
    v_mfma_f32_16x16x32_bf16 a[208:211], v[164:167], a[8:11], a[208:211]
    v_add_f32 v107, v107, v46
    ds_write_b128 v11, a[196:199] offset:192
    v_mfma_f32_16x16x32_bf16 a[208:211], v[184:187], a[12:15], a[208:211]
    v_mfma_f32_16x16x32_bf16 a[212:215], v[168:171], a[8:11], a[212:215]
    v_add_f32 v108, v108, v46
    v_mfma_f32_16x16x32_bf16 a[212:215], v[188:191], a[12:15], a[212:215]
    v_add_f32 v109, v109, v46
    ds_write_b128 v11, a[200:203] offset:256
    v_mfma_f32_16x16x32_bf16 a[216:219], v[172:175], a[8:11], a[216:219]
    v_mfma_f32_16x16x32_bf16 a[216:219], v[192:195], a[12:15], a[216:219]
    v_add_f32 v110, v110, v46
    v_mfma_f32_16x16x32_bf16 a[220:223], v[176:179], a[8:11], a[220:223]
    v_mfma_f32_16x16x32_bf16 a[220:223], v[196:199], a[12:15], a[220:223]
    v_add_f32 v111, v111, v46
    s_waitcnt vmcnt(8)
    v_mfma_f32_16x16x32_bf16 a[204:207], v[200:203], a[16:19], a[204:207]
    s_waitcnt vmcnt(6)
    v_lshlrev_b32 v48, 16, v36
    v_mfma_f32_16x16x32_bf16 a[204:207], v[220:223], a[20:23], a[204:207]
    s_waitcnt lgkmcnt(0)
    s_barrier
    v_mfma_f32_16x16x32_bf16 a[208:211], v[204:207], a[16:19], a[208:211]
    ds_read_b128 v[72:75], v9 offset:0
    ds_read_b128 v[76:79], v9 offset:16
    v_mfma_f32_16x16x32_bf16 a[208:211], v[224:227], a[20:23], a[208:211]
    ds_read_b128 v[80:83], v9 offset:20480
    v_and_b32 v49, 0xffff0000, v36
    v_mfma_f32_16x16x32_bf16 a[212:215], v[208:211], a[16:19], a[212:215]
    ds_read_b128 v[84:87], v9 offset:20496
    ds_read_b128 v[88:91], v12 offset:0
    v_mfma_f32_16x16x32_bf16 a[212:215], v[228:231], a[20:23], a[212:215]
    ds_read_b128 v[92:95], v12 offset:16
    v_lshlrev_b32 v50, 16, v37
    v_mfma_f32_16x16x32_bf16 a[216:219], v[212:215], a[16:19], a[216:219]
    ds_read_b128 v[96:99], v12 offset:20480
    ds_read_b128 v[100:103], v12 offset:20496
    v_mfma_f32_16x16x32_bf16 a[216:219], v[232:235], a[20:23], a[216:219]
    v_and_b32 v51, 0xffff0000, v37
    v_lshlrev_b32 v52, 16, v38
    v_mfma_f32_16x16x32_bf16 a[220:223], v[216:219], a[16:19], a[220:223]
    v_and_b32 v53, 0xffff0000, v38
    v_lshlrev_b32 v54, 16, v39
    v_mfma_f32_16x16x32_bf16 a[220:223], v[236:239], a[20:23], a[220:223]
    s_waitcnt vmcnt(5)
    v_mfma_f32_16x16x32_bf16 a[204:207], v[240:243], a[24:27], a[204:207]
    s_waitcnt lgkmcnt(6)
    v_add_f32 v104, v104, v72
    v_mfma_f32_16x16x32_bf16 a[204:207], a[244:247], a[28:31], a[204:207]
    v_add_f32 v105, v105, v73
    v_add_f32 v106, v106, v74
    v_mfma_f32_16x16x32_bf16 a[208:211], v[244:247], a[24:27], a[208:211]
    v_add_f32 v107, v107, v75
    v_add_f32 v108, v108, v76
    v_mfma_f32_16x16x32_bf16 a[208:211], a[248:251], a[28:31], a[208:211]
    v_add_f32 v109, v109, v77
    v_add_f32 v110, v110, v78
    v_mfma_f32_16x16x32_bf16 a[212:215], v[248:251], a[24:27], a[212:215]
    v_add_f32 v111, v111, v79
    s_waitcnt lgkmcnt(4)
    v_mfma_f32_16x16x32_bf16 a[212:215], a[252:255], a[28:31], a[212:215]
    v_add_f32 v104, v104, v80
    v_and_b32 v55, 0xffff0000, v39
    v_mfma_f32_16x16x32_bf16 a[216:219], v[252:255], a[24:27], a[216:219]
    v_add_f32 v105, v105, v81
    v_add_f32 v106, v106, v82
    v_mfma_f32_16x16x32_bf16 a[216:219], a[48:51], a[28:31], a[216:219]
    v_add_f32 v107, v107, v83
    v_add_f32 v48, v48, v47
    v_mfma_f32_16x16x32_bf16 a[220:223], a[240:243], a[24:27], a[220:223]
    v_add_f32 v108, v108, v84
    v_add_f32 v109, v109, v85
    v_mfma_f32_16x16x32_bf16 a[220:223], a[52:55], a[28:31], a[220:223]
    v_add_f32 v110, v110, v86
    s_waitcnt vmcnt(3)
    v_mfma_f32_16x16x32_bf16 a[204:207], a[56:59], a[32:35], a[204:207]
    v_add_f32 v111, v111, v87
    v_add_f32 v49, v49, v47
    v_mfma_f32_16x16x32_bf16 a[204:207], a[76:79], a[36:39], a[204:207]
    s_waitcnt lgkmcnt(2)
    s_waitcnt vmcnt(0)
    v_mfma_f32_16x16x32_bf16 a[204:207], a[96:99], a[40:43], a[204:207]
    v_add_f32 v104, v104, v88
    v_add_f32 v105, v105, v89
    v_mfma_f32_16x16x32_bf16 a[204:207], a[116:119], a[44:47], a[204:207]
    v_add_f32 v50, v50, v47
    v_add_f32 v106, v106, v90
    v_mfma_f32_16x16x32_bf16 a[208:211], a[60:63], a[32:35], a[208:211]
    v_add_f32 v107, v107, v91
    v_add_f32 v108, v108, v92
    v_mfma_f32_16x16x32_bf16 a[208:211], a[80:83], a[36:39], a[208:211]
    v_add_f32 v51, v51, v47
    v_add_f32 v109, v109, v93
    v_mfma_f32_16x16x32_bf16 a[208:211], a[100:103], a[40:43], a[208:211]
    v_add_f32 v110, v110, v94
    v_add_f32 v111, v111, v95
    v_mfma_f32_16x16x32_bf16 a[208:211], a[120:123], a[44:47], a[208:211]
    ds_write_b128 v11, a[204:207] offset:5376
    v_mfma_f32_16x16x32_bf16 a[212:215], a[64:67], a[32:35], a[212:215]
    v_add_f32 v52, v52, v47
    s_waitcnt lgkmcnt(1)
    v_mfma_f32_16x16x32_bf16 a[212:215], a[84:87], a[36:39], a[212:215]
    v_add_f32 v104, v104, v96
    v_add_f32 v105, v105, v97
    v_mfma_f32_16x16x32_bf16 a[212:215], a[104:107], a[40:43], a[212:215]
    v_add_f32 v106, v106, v98
    v_add_f32 v53, v53, v47
    v_mfma_f32_16x16x32_bf16 a[212:215], a[124:127], a[44:47], a[212:215]
    ds_write_b128 v11, a[208:211] offset:5440
    v_mfma_f32_16x16x32_bf16 a[216:219], a[68:71], a[32:35], a[216:219]
    v_add_f32 v107, v107, v99
    v_add_f32 v108, v108, v100
    v_mfma_f32_16x16x32_bf16 a[216:219], a[88:91], a[36:39], a[216:219]
    v_add_f32 v109, v109, v101
    v_add_f32 v54, v54, v47
    v_mfma_f32_16x16x32_bf16 a[216:219], a[108:111], a[40:43], a[216:219]
    v_add_f32 v110, v110, v102
    v_add_f32 v111, v111, v103
    v_mfma_f32_16x16x32_bf16 a[216:219], a[128:131], a[44:47], a[216:219]
    ds_write_b128 v11, a[212:215] offset:5504
    v_mfma_f32_16x16x32_bf16 a[220:223], a[72:75], a[32:35], a[220:223]
    v_add_f32 v55, v55, v47
    v_cvt_pk_bf16_f32 v112, v104, v105
    v_mfma_f32_16x16x32_bf16 a[220:223], a[92:95], a[36:39], a[220:223]
    v_cvt_pk_bf16_f32 v113, v106, v107
    v_cvt_pk_bf16_f32 v114, v108, v109
    v_mfma_f32_16x16x32_bf16 a[220:223], a[112:115], a[40:43], a[220:223]
    v_cvt_pk_bf16_f32 v115, v110, v111
    s_add_u32 s3, s59, 1310720
    buffer_store_dwordx4 v[112:115], v8, s[20:23], s3 offen nt
    v_mfma_f32_16x16x32_bf16 a[220:223], a[132:135], a[44:47], a[220:223]
    v_accvgpr_read_b32 v27, a204
    v_cmp_u_f32 vcc, v27, v27
    s_cbranch_vccnz RT_n3
BK_n3:
    ds_write_b128 v11, a[216:219] offset:5568
    s_nop 3
    ds_write_b128 v11, a[220:223] offset:5632
    s_waitcnt lgkmcnt(0)
    s_barrier
    ds_read_b128 v[72:75], v9 offset:5376
    ds_read_b128 v[76:79], v9 offset:5392
    ds_read_b128 v[80:83], v9 offset:25856
    ds_read_b128 v[84:87], v9 offset:25872
    ds_read_b128 v[88:91], v12 offset:5376
    ds_read_b128 v[92:95], v12 offset:5392
    ds_read_b128 v[96:99], v12 offset:25856
    ds_read_b128 v[100:103], v12 offset:25872
    s_waitcnt lgkmcnt(6)
    v_pk_add_f32 v[48:49], v[48:49], v[72:73]
    v_pk_add_f32 v[50:51], v[50:51], v[74:75]
    v_pk_add_f32 v[52:53], v[52:53], v[76:77]
    v_pk_add_f32 v[54:55], v[54:55], v[78:79]
    s_waitcnt lgkmcnt(4)
    v_pk_add_f32 v[48:49], v[48:49], v[80:81]
    v_pk_add_f32 v[50:51], v[50:51], v[82:83]
    v_pk_add_f32 v[52:53], v[52:53], v[84:85]
    v_pk_add_f32 v[54:55], v[54:55], v[86:87]
    s_waitcnt lgkmcnt(2)
    v_pk_add_f32 v[48:49], v[48:49], v[88:89]
    v_pk_add_f32 v[50:51], v[50:51], v[90:91]
    v_pk_add_f32 v[52:53], v[52:53], v[92:93]
    v_pk_add_f32 v[54:55], v[54:55], v[94:95]
    s_waitcnt lgkmcnt(0)
    v_pk_add_f32 v[48:49], v[48:49], v[96:97]
    v_pk_add_f32 v[50:51], v[50:51], v[98:99]
    v_pk_add_f32 v[52:53], v[52:53], v[100:101]
    v_pk_add_f32 v[54:55], v[54:55], v[102:103]
    v_cvt_pk_bf16_f32 v56, v48, v49
    v_cvt_pk_bf16_f32 v57, v50, v51
    v_cvt_pk_bf16_f32 v58, v52, v53
    v_cvt_pk_bf16_f32 v59, v54, v55
    s_add_u32 s3, s59, 1966080
    buffer_store_dwordx4 v[56:59], v8, s[20:23], s3 offen nt
    s_lshl2_add_u32 s3, s2, s28
    s_cmp_lg_u32 s3, 0
    s_cbranch_scc1 L_nobump
    s_mov_b32 s3, 5193728
    buffer_store_dword v23, off, s[8:11], s3 sc1
L_nobump:
L_end:
    s_endpgm
RT_f1:
    s_add_u32 s38, s38, 1
    s_cmp_gt_u32 s38, 400000
    s_cbranch_scc1 BK_f1
    s_mov_b32 s3, 5029888
    v_lshlrev_b32 v225, 4, v0
    buffer_load_dword v224, v225, s[8:11], s3 offen sc1
    s_waitcnt vmcnt(0)
    v_cmp_ne_u32 vcc, s34, v224
    s_cbranch_vccnz RT_f1
    s_branch BK_f1
RT_bm:
    s_add_u32 s38, s38, 1
    s_cmp_gt_u32 s38, 400000
    s_cbranch_scc1 BK_bm
    s_mov_b32 s3, 2228224
    buffer_load_dword v12, v26, s[8:11], s3 offen offset:0 sc1
    buffer_load_dword v13, v26, s[8:11], s3 offen offset:64 sc1
    s_waitcnt vmcnt(0)
    v_max_u32 v24, v12, v13
    v_cmp_eq_u32 vcc, -1, v24
    s_cbranch_vccnz RT_bm
    s_branch BK_bm
RT_bv:
    s_add_u32 s38, s38, 1
    s_cmp_gt_u32 s38, 400000
    s_cbranch_scc1 BK_bv
    s_add_u32 s3, s46, 0
    buffer_load_dword v32, v27, s[8:11], s3 offen offset:0 sc1
    buffer_load_dword v33, v27, s[8:11], s3 offen offset:1664 sc1
    s_add_u32 s3, s46, 3328
    buffer_load_dword v34, v27, s[8:11], s3 offen offset:0 sc1
    buffer_load_dword v35, v27, s[8:11], s3 offen offset:1664 sc1
    s_add_u32 s3, s46, 13312
    buffer_load_dword v36, v27, s[8:11], s3 offen offset:0 sc1
    buffer_load_dword v37, v27, s[8:11], s3 offen offset:1664 sc1
    s_add_u32 s3, s46, 16640
    buffer_load_dword v38, v27, s[8:11], s3 offen offset:0 sc1
    buffer_load_dword v39, v27, s[8:11], s3 offen offset:1664 sc1
    s_add_u32 s3, s46, 26624
    buffer_load_dword v40, v27, s[8:11], s3 offen offset:0 sc1
    buffer_load_dword v41, v27, s[8:11], s3 offen offset:1664 sc1
    s_add_u32 s3, s46, 29952
    buffer_load_dword v42, v27, s[8:11], s3 offen offset:0 sc1
    buffer_load_dword v43, v27, s[8:11], s3 offen offset:1664 sc1
    s_add_u32 s3, s46, 39936
    buffer_load_dword v44, v27, s[8:11], s3 offen offset:0 sc1
    buffer_load_dword v45, v27, s[8:11], s3 offen offset:1664 sc1
    s_add_u32 s3, s46, 43264
    buffer_load_dword v46, v27, s[8:11], s3 offen offset:0 sc1
    buffer_load_dword v47, v27, s[8:11], s3 offen offset:1664 sc1
    s_waitcnt vmcnt(0)
    v_max3_u32 v24, v32, v33, v34
    v_max3_u32 v24, v24, v35, v36
    v_max3_u32 v24, v24, v37, v38
    v_max3_u32 v24, v24, v39, v40
    v_max3_u32 v24, v24, v41, v42
    v_max3_u32 v24, v24, v43, v44
    v_max3_u32 v24, v24, v45, v46
    v_max_u32 v24, v24, v47
    v_cmp_eq_u32 vcc, -1, v24
    s_cbranch_vccnz RT_bv
    s_branch BK_bv
RT_rf:
    s_add_u32 s38, s38, 1
    s_cmp_gt_u32 s38, 400000
    s_cbranch_scc1 BK_rf
    s_mov_b32 s3, 5046272
    buffer_load_dword v209, v225, s[8:11], s3 offen sc1
    s_waitcnt vmcnt(0)
    v_cmp_ne_u32 vcc, s34, v209
    s_cbranch_vccnz RT_rf
    s_branch BK_rf
RT_h0:
    s_add_u32 s38, s38, 1
    s_cmp_gt_u32 s38, 400000
    s_cbranch_scc1 BK_h0
    s_add_u32 m0, s36, 0
    v_add_u32 v0, 0, v4
    buffer_load_dwordx4 v0, s[8:11], s29 offen offset:0 sc1 lds
    buffer_load_dwordx4 v0, s[8:11], s30 offen offset:1024 sc1 lds
    buffer_load_dwordx4 v0, s[8:11], s31 offen offset:2048 sc1 lds
    buffer_load_dwordx4 v0, s[8:11], s37 offen offset:3072 sc1 lds
    s_add_u32 m0, s36, 4096
    s_nop 0
    buffer_load_dwordx4 v0, s[8:11], s48 offen offset:0 sc1 lds
    s_add_u32 m0, s36, 5120
    v_add_u32 v0, 327680, v4
    buffer_load_dwordx4 v0, s[8:11], s29 offen offset:0 sc1 lds
    buffer_load_dwordx4 v0, s[8:11], s30 offen offset:1024 sc1 lds
    buffer_load_dwordx4 v0, s[8:11], s31 offen offset:2048 sc1 lds
    buffer_load_dwordx4 v0, s[8:11], s37 offen offset:3072 sc1 lds
    s_add_u32 m0, s36, 9216
    s_nop 0
    buffer_load_dwordx4 v0, s[8:11], s48 offen offset:0 sc1 lds
    s_waitcnt vmcnt(0)
    ds_read2st64_b32 v[72:73], v5 offset0:0 offset1:4
    ds_read2st64_b32 v[74:75], v5 offset0:8 offset1:12
    ds_read_b32 v76, v5 offset:4096
    s_waitcnt lgkmcnt(0)
    v_max3_u32 v77, v72, v73, v74
    v_max3_u32 v77, v77, v75, v76
    v_cmp_eq_u32 vcc, -1, v77
    s_cbranch_vccnz RT_h0
    s_branch BK_h0
RT_ss:
    s_add_u32 s38, s38, 1
    s_cmp_gt_u32 s38, 400000
    s_cbranch_scc1 BK_ss
    buffer_load_dword v96, v25, s[8:11], s40 offen offset:0 sc1
    buffer_load_dword v97, v25, s[8:11], s40 offen offset:256 sc1
    buffer_load_dword v101, v25, s[8:11], s41 offen offset:0 sc1
    buffer_load_dword v102, v25, s[8:11], s41 offen offset:256 sc1
    s_waitcnt vmcnt(0)
    v_max3_u32 v106, v96, v97, v101
    v_max_u32 v106, v106, v102
    v_cmp_eq_u32 vcc, -1, v106
    s_cbranch_vccnz RT_ss
    s_branch BK_ss
RT_h1:
    s_add_u32 s38, s38, 1
    s_cmp_gt_u32 s38, 400000
    s_cbranch_scc1 BK_h1
    s_add_u32 m0, s36, 5120
    v_add_u32 v0, 327680, v4
    buffer_load_dwordx4 v0, s[8:11], s29 offen offset:0 sc1 lds
    buffer_load_dwordx4 v0, s[8:11], s30 offen offset:1024 sc1 lds
    buffer_load_dwordx4 v0, s[8:11], s31 offen offset:2048 sc1 lds
    buffer_load_dwordx4 v0, s[8:11], s37 offen offset:3072 sc1 lds
    s_add_u32 m0, s36, 9216
    s_nop 0
    buffer_load_dwordx4 v0, s[8:11], s48 offen offset:0 sc1 lds
    s_waitcnt vmcnt(0)
    ds_read2st64_b32 v[72:73], v5 offset0:20 offset1:24
    ds_read2st64_b32 v[74:75], v5 offset0:28 offset1:32
    ds_read_b32 v76, v5 offset:9216
    s_waitcnt lgkmcnt(0)
    v_max3_u32 v77, v72, v73, v74
    v_max3_u32 v77, v77, v75, v76
    v_cmp_eq_u32 vcc, -1, v77
    s_cbranch_vccnz RT_h1
    s_branch BK_h1
RT_pf0:
    s_add_u32 s38, s38, 1
    s_cmp_gt_u32 s38, 400000
    s_cbranch_scc1 BK_pf0
    buffer_load_dword v27, v6, s[8:11], s43 offen offset:0 sc1
    s_waitcnt vmcnt(0)
    v_cmp_ne_u32 vcc, s34, v27
    s_cbranch_vccnz RT_pf0
    s_branch BK_pf0
RT_pf1:
    s_add_u32 s38, s38, 1
    s_cmp_gt_u32 s38, 400000
    s_cbranch_scc1 BK_pf1
    buffer_load_dword v27, v6, s[8:11], s43 offen offset:128 sc1
    s_waitcnt vmcnt(0)
    v_cmp_ne_u32 vcc, s34, v27
    s_cbranch_vccnz RT_pf1
    s_branch BK_pf1
RT_pf2:
    s_add_u32 s38, s38, 1
    s_cmp_gt_u32 s38, 400000
    s_cbranch_scc1 BK_pf2
    buffer_load_dword v27, v6, s[8:11], s43 offen offset:256 sc1
    s_waitcnt vmcnt(0)
    v_cmp_ne_u32 vcc, s34, v27
    s_cbranch_vccnz RT_pf2
    s_branch BK_pf2
RT_n3:
    s_add_u32 s38, s38, 1
    s_cmp_gt_u32 s38, 400000
    s_cbranch_scc1 RD_n3
    s_add_u32 s3, s52, 4718592
    buffer_load_dwordx4 a[0:3], v4, s[8:11], s3 offen offset:0 sc1
    buffer_load_dwordx4 a[4:7], v4, s[8:11], s3 offen offset:1024 sc1
    buffer_load_dwordx4 a[8:11], v4, s[8:11], s3 offen offset:2048 sc1
    buffer_load_dwordx4 a[12:15], v4, s[8:11], s3 offen offset:3072 sc1
    s_add_u32 s3, s52, 4722688
    buffer_load_dwordx4 a[16:19], v4, s[8:11], s3 offen offset:0 sc1
    buffer_load_dwordx4 a[20:23], v4, s[8:11], s3 offen offset:1024 sc1
    buffer_load_dwordx4 a[24:27], v4, s[8:11], s3 offen offset:2048 sc1
    buffer_load_dwordx4 a[28:31], v4, s[8:11], s3 offen offset:3072 sc1
    s_add_u32 s3, s52, 4726784
    buffer_load_dwordx4 a[32:35], v4, s[8:11], s3 offen offset:0 sc1
    buffer_load_dwordx4 a[36:39], v4, s[8:11], s3 offen offset:1024 sc1
    buffer_load_dwordx4 a[40:43], v4, s[8:11], s3 offen offset:2048 sc1
    buffer_load_dwordx4 a[44:47], v4, s[8:11], s3 offen offset:3072 sc1
    s_waitcnt vmcnt(0)
    v_mov_b32 v27, 0
    v_accvgpr_read_b32 v20, a0
    v_accvgpr_read_b32 v21, a1
    v_max3_u32 v27, v27, v20, v21
    v_accvgpr_read_b32 v20, a2
    v_accvgpr_read_b32 v21, a3
    v_max3_u32 v27, v27, v20, v21
    v_accvgpr_read_b32 v20, a4
    v_accvgpr_read_b32 v21, a5
    v_max3_u32 v27, v27, v20, v21
    v_accvgpr_read_b32 v20, a6
    v_accvgpr_read_b32 v21, a7
    v_max3_u32 v27, v27, v20, v21
    v_accvgpr_read_b32 v20, a8
    v_accvgpr_read_b32 v21, a9
    v_max3_u32 v27, v27, v20, v21
    v_accvgpr_read_b32 v20, a10
    v_accvgpr_read_b32 v21, a11
    v_max3_u32 v27, v27, v20, v21
    v_accvgpr_read_b32 v20, a12
    v_accvgpr_read_b32 v21, a13
    v_max3_u32 v27, v27, v20, v21
    v_accvgpr_read_b32 v20, a14
    v_accvgpr_read_b32 v21, a15
    v_max3_u32 v27, v27, v20, v21
    v_accvgpr_read_b32 v20, a16
    v_accvgpr_read_b32 v21, a17
    v_max3_u32 v27, v27, v20, v21
    v_accvgpr_read_b32 v20, a18
    v_accvgpr_read_b32 v21, a19
    v_max3_u32 v27, v27, v20, v21
    v_accvgpr_read_b32 v20, a20
    v_accvgpr_read_b32 v21, a21
    v_max3_u32 v27, v27, v20, v21
    v_accvgpr_read_b32 v20, a22
    v_accvgpr_read_b32 v21, a23
    v_max3_u32 v27, v27, v20, v21
    v_accvgpr_read_b32 v20, a24
    v_accvgpr_read_b32 v21, a25
    v_max3_u32 v27, v27, v20, v21
    v_accvgpr_read_b32 v20, a26
    v_accvgpr_read_b32 v21, a27
    v_max3_u32 v27, v27, v20, v21
    v_accvgpr_read_b32 v20, a28
    v_accvgpr_read_b32 v21, a29
    v_max3_u32 v27, v27, v20, v21
    v_accvgpr_read_b32 v20, a30
    v_accvgpr_read_b32 v21, a31
    v_max3_u32 v27, v27, v20, v21
    v_accvgpr_read_b32 v20, a32
    v_accvgpr_read_b32 v21, a33
    v_max3_u32 v27, v27, v20, v21
    v_accvgpr_read_b32 v20, a34
    v_accvgpr_read_b32 v21, a35
    v_max3_u32 v27, v27, v20, v21
    v_accvgpr_read_b32 v20, a36
    v_accvgpr_read_b32 v21, a37
    v_max3_u32 v27, v27, v20, v21
    v_accvgpr_read_b32 v20, a38
    v_accvgpr_read_b32 v21, a39
    v_max3_u32 v27, v27, v20, v21
    v_accvgpr_read_b32 v20, a40
    v_accvgpr_read_b32 v21, a41
    v_max3_u32 v27, v27, v20, v21
    v_accvgpr_read_b32 v20, a42
    v_accvgpr_read_b32 v21, a43
    v_max3_u32 v27, v27, v20, v21
    v_accvgpr_read_b32 v20, a44
    v_accvgpr_read_b32 v21, a45
    v_max3_u32 v27, v27, v20, v21
    v_accvgpr_read_b32 v20, a46
    v_accvgpr_read_b32 v21, a47
    v_max3_u32 v27, v27, v20, v21
    v_cmp_eq_u32 vcc, -1, v27
    s_cbranch_vccnz RT_n3
RD_n3:
    v_mfma_f32_16x16x32_bf16 a[204:207], v[120:123], a[0:3], 0
    v_mfma_f32_16x16x32_bf16 a[204:207], v[140:143], a[4:7], a[204:207]
    v_mfma_f32_16x16x32_bf16 a[204:207], v[160:163], a[8:11], a[204:207]
    v_mfma_f32_16x16x32_bf16 a[204:207], v[180:183], a[12:15], a[204:207]
    v_mfma_f32_16x16x32_bf16 a[204:207], v[200:203], a[16:19], a[204:207]
    v_mfma_f32_16x16x32_bf16 a[204:207], v[220:223], a[20:23], a[204:207]
    v_mfma_f32_16x16x32_bf16 a[204:207], v[240:243], a[24:27], a[204:207]
    v_mfma_f32_16x16x32_bf16 a[204:207], a[244:247], a[28:31], a[204:207]
    v_mfma_f32_16x16x32_bf16 a[204:207], a[56:59], a[32:35], a[204:207]
    v_mfma_f32_16x16x32_bf16 a[204:207], a[76:79], a[36:39], a[204:207]
    v_mfma_f32_16x16x32_bf16 a[204:207], a[96:99], a[40:43], a[204:207]
    v_mfma_f32_16x16x32_bf16 a[204:207], a[116:119], a[44:47], a[204:207]
    v_mfma_f32_16x16x32_bf16 a[208:211], v[124:127], a[0:3], 0
    v_mfma_f32_16x16x32_bf16 a[208:211], v[144:147], a[4:7], a[208:211]
    v_mfma_f32_16x16x32_bf16 a[208:211], v[164:167], a[8:11], a[208:211]
    v_mfma_f32_16x16x32_bf16 a[208:211], v[184:187], a[12:15], a[208:211]
    v_mfma_f32_16x16x32_bf16 a[208:211], v[204:207], a[16:19], a[208:211]
    v_mfma_f32_16x16x32_bf16 a[208:211], v[224:227], a[20:23], a[208:211]
    v_mfma_f32_16x16x32_bf16 a[208:211], v[244:247], a[24:27], a[208:211]
    v_mfma_f32_16x16x32_bf16 a[208:211], a[248:251], a[28:31], a[208:211]
    v_mfma_f32_16x16x32_bf16 a[208:211], a[60:63], a[32:35], a[208:211]
    v_mfma_f32_16x16x32_bf16 a[208:211], a[80:83], a[36:39], a[208:211]
    v_mfma_f32_16x16x32_bf16 a[208:211], a[100:103], a[40:43], a[208:211]
    v_mfma_f32_16x16x32_bf16 a[208:211], a[120:123], a[44:47], a[208:211]
    v_mfma_f32_16x16x32_bf16 a[212:215], v[128:131], a[0:3], 0
    v_mfma_f32_16x16x32_bf16 a[212:215], v[148:151], a[4:7], a[212:215]
    v_mfma_f32_16x16x32_bf16 a[212:215], v[168:171], a[8:11], a[212:215]
    v_mfma_f32_16x16x32_bf16 a[212:215], v[188:191], a[12:15], a[212:215]
    v_mfma_f32_16x16x32_bf16 a[212:215], v[208:211], a[16:19], a[212:215]
    v_mfma_f32_16x16x32_bf16 a[212:215], v[228:231], a[20:23], a[212:215]
    v_mfma_f32_16x16x32_bf16 a[212:215], v[248:251], a[24:27], a[212:215]
    v_mfma_f32_16x16x32_bf16 a[212:215], a[252:255], a[28:31], a[212:215]
    v_mfma_f32_16x16x32_bf16 a[212:215], a[64:67], a[32:35], a[212:215]
    v_mfma_f32_16x16x32_bf16 a[212:215], a[84:87], a[36:39], a[212:215]
    v_mfma_f32_16x16x32_bf16 a[212:215], a[104:107], a[40:43], a[212:215]
    v_mfma_f32_16x16x32_bf16 a[212:215], a[124:127], a[44:47], a[212:215]
    v_mfma_f32_16x16x32_bf16 a[216:219], v[132:135], a[0:3], 0
    v_mfma_f32_16x16x32_bf16 a[216:219], v[152:155], a[4:7], a[216:219]
    v_mfma_f32_16x16x32_bf16 a[216:219], v[172:175], a[8:11], a[216:219]
    v_mfma_f32_16x16x32_bf16 a[216:219], v[192:195], a[12:15], a[216:219]
    v_mfma_f32_16x16x32_bf16 a[216:219], v[212:215], a[16:19], a[216:219]
    v_mfma_f32_16x16x32_bf16 a[216:219], v[232:235], a[20:23], a[216:219]
    v_mfma_f32_16x16x32_bf16 a[216:219], v[252:255], a[24:27], a[216:219]
    v_mfma_f32_16x16x32_bf16 a[216:219], a[48:51], a[28:31], a[216:219]
    v_mfma_f32_16x16x32_bf16 a[216:219], a[68:71], a[32:35], a[216:219]
    v_mfma_f32_16x16x32_bf16 a[216:219], a[88:91], a[36:39], a[216:219]
    v_mfma_f32_16x16x32_bf16 a[216:219], a[108:111], a[40:43], a[216:219]
    v_mfma_f32_16x16x32_bf16 a[216:219], a[128:131], a[44:47], a[216:219]
    v_mfma_f32_16x16x32_bf16 a[220:223], v[136:139], a[0:3], 0
    v_mfma_f32_16x16x32_bf16 a[220:223], v[156:159], a[4:7], a[220:223]
    v_mfma_f32_16x16x32_bf16 a[220:223], v[176:179], a[8:11], a[220:223]
    v_mfma_f32_16x16x32_bf16 a[220:223], v[196:199], a[12:15], a[220:223]
    v_mfma_f32_16x16x32_bf16 a[220:223], v[216:219], a[16:19], a[220:223]
    v_mfma_f32_16x16x32_bf16 a[220:223], v[236:239], a[20:23], a[220:223]
    v_mfma_f32_16x16x32_bf16 a[220:223], a[240:243], a[24:27], a[220:223]
    v_mfma_f32_16x16x32_bf16 a[220:223], a[52:55], a[28:31], a[220:223]
    v_mfma_f32_16x16x32_bf16 a[220:223], a[72:75], a[32:35], a[220:223]
    v_mfma_f32_16x16x32_bf16 a[220:223], a[92:95], a[36:39], a[220:223]
    v_mfma_f32_16x16x32_bf16 a[220:223], a[112:115], a[40:43], a[220:223]
    v_mfma_f32_16x16x32_bf16 a[220:223], a[132:135], a[44:47], a[220:223]
    ds_write_b128 v11, a[204:207] offset:5376
    ds_write_b128 v11, a[208:211] offset:5440
    ds_write_b128 v11, a[212:215] offset:5504
    s_nop 7
    s_branch BK_n3

L_codeend:
.fill (33024 - (L_codeend - sequential_preLN__spectral_fnet__glu_gated_glu__prompt_kernel))/4, 4, 0xbf810000
.section .rodata,"a"
.p2align 6
.amdhsa_kernel sequential_preLN__spectral_fnet__glu_gated_glu__prompt_kernel
  .amdhsa_next_free_vgpr 512
  .amdhsa_next_free_sgpr 102
  .amdhsa_accum_offset 256
  .amdhsa_group_segment_fixed_size 0
  .amdhsa_kernarg_size 96
  .amdhsa_user_sgpr_count 2
  .amdhsa_user_sgpr_kernarg_segment_ptr 1
  .amdhsa_system_sgpr_workgroup_id_x 1
.end_amdhsa_kernel
```
